```python
import torch

def _softmax(x, axis=-1):
    return torch.softmax(x, dim=axis)
def _gelu(x):
    return torch.nn.functional.gelu(x, approximate="tanh")
def _silu(x):
    return torch.nn.functional.silu(x)
def _sigmoid(x):
    return torch.sigmoid(x)
def _layernorm(x, axis=-1, eps=1e-5):
    m = x.mean(dim=axis, keepdim=True)
    v = x.var(dim=axis, keepdim=True, unbiased=False)
    return (x - m) / torch.sqrt(v + eps)
def _scatter_add(tgt, idx, src, axis=0):
    return tgt.clone().index_add_(axis, idx, src)
def _segment_sum(src, seg, n):
    out = torch.zeros((n,) + src.shape[1:], dtype=src.dtype)
    return out.index_add_(0, seg, src)
def _pad(x, pw):
    flat = tuple(v for pair in reversed(pw) for v in pair)
    return torch.nn.functional.pad(x, flat)

kernel_name = 'parallel_sum__sliding_block_cached__mixer_channel_mlp__decode'

def setup_inputs():

    _w = (lambda a: (lambda t: t.to(torch.bfloat16) if t.is_floating_point() else t)(torch.as_tensor(a)))
    def _A_setup():
        B, Sq, D = 1, 1, 448
        Hq, Hkv, Sk, Dh = 16, 8, 32768, 256
        assert Hq % Hkv == 0, (Hq, Hkv)
        return {
            "x": _w((lambda *s: torch.randn(*s, dtype=torch.bfloat16) * 0.05)(B, Sq, D)),
            "k_cache": _w((lambda *s: torch.randn(*s, dtype=torch.bfloat16) * 3.2)(B, Hkv, Sk, Dh)),
            "v_cache": _w((lambda *s: torch.randn(*s, dtype=torch.bfloat16) * 0.4)(B, Hkv, Sk, Dh)),
            "wq": _w((lambda *s: torch.randn(*s, dtype=torch.bfloat16) * 3.2)(D, Hq * Dh) * (D ** -0.5)),
            "wo": _w((lambda *s: torch.randn(*s, dtype=torch.bfloat16) * 0.4)(Hq * Dh, D) * ((Hq * Dh) ** -0.5)),
        }
    _A_in = _A_setup()

    def _B_setup():
        B, S, D, F = 1, 1, 448, 1792
        return {
            "x": _w((lambda *s: torch.randn(*s, dtype=torch.bfloat16) * 0.05)(B, S, D)),
            "w1": _w((lambda *s: torch.randn(*s, dtype=torch.bfloat16) * 3.2)(D, F) * (D ** -0.5)),
            "b1": _w((lambda *s: torch.randn(*s, dtype=torch.bfloat16) * 1.6)(F)),
            "w2": _w((lambda *s: torch.randn(*s, dtype=torch.bfloat16) * 0.1)(F, D) * (F ** -0.5)),
            "b2": _w((lambda *s: torch.randn(*s, dtype=torch.bfloat16) * 0.1)(D)),
        }
    _B_in = _B_setup()

    return {
        "A_x": _A_in["x"],
        "A_k_cache": _A_in["k_cache"],
        "A_v_cache": _A_in["v_cache"],
        "A_wq": _A_in["wq"],
        "A_wo": _A_in["wo"],
        "B_x": _B_in["x"],
        "B_w1": _B_in["w1"],
        "B_b1": _B_in["b1"],
        "B_w2": _B_in["w2"],
        "B_b2": _B_in["b2"],
    }

def reference(A_x, A_k_cache, A_v_cache, A_wq, A_wo, B_x, B_w1, B_b1, B_w2, B_b2):
    def _A_ref(x, k_cache, v_cache, wq, wo):
        B, Sq, D = x.shape
        Hq, Dh = 16, 256
        Hkv, Sk = k_cache.shape[1], k_cache.shape[2]
        W = min(4096, max(256, Sk // 4))
        rep = Hq // Hkv
        q = (lambda x, *d: x.permute(*d))((x @ wq).reshape(B, Sq, Hq, Dh), 0, 2, 1, 3)
        k = (lambda x, n, axis: torch.repeat_interleave(x, n, dim=axis))(k_cache[:, :, Sk - W:, :], rep, axis=1)
        v = (lambda x, n, axis: torch.repeat_interleave(x, n, dim=axis))(v_cache[:, :, Sk - W:, :], rep, axis=1)
        scores = torch.einsum("bhqd,bhkd->bhqk", q, k) * (Dh ** -0.5)
        p = _softmax(scores, axis=-1)
        o = torch.einsum("bhqk,bhkd->bhqd", p, v)
        return (lambda x, *d: x.permute(*d))(o, 0, 2, 1, 3).reshape(B, Sq, Hq * Dh) @ wo

    def _B_ref(x, w1, b1, w2, b2):
        y = _layernorm(x, axis=-1)
        h = _gelu(torch.einsum("bsd,df->bsf", y, w1) + b1)
        return torch.einsum("bsf,fd->bsd", h, w2) + b2

    x = A_x
    xn = _layernorm(x, axis=-1)
    return x + _A_ref(xn, A_k_cache, A_v_cache, A_wq, A_wo) + _B_ref(xn, B_w1, B_b1, B_w2, B_b2)
```

```asm
; @launch grid=(256,1,1) block=(640,1,1) lds=24576
.amdgcn_target "amdgcn-amd-amdhsa--gfx950"
.text
.globl parallel_sum__sliding_block_cached__mixer_channel_mlp__decode_kernel
.p2align 8
.type parallel_sum__sliding_block_cached__mixer_channel_mlp__decode_kernel,@function
parallel_sum__sliding_block_cached__mixer_channel_mlp__decode_kernel:
    s_cmp_ge_u32 s2, 256
    s_cbranch_scc1 L_end
    s_load_dwordx16 s[16:31], s[0:1], 0
    s_load_dwordx8 s[32:39], s[0:1], 64
    s_load_dwordx2 s[40:41], s[0:1], 96
    v_lshrrev_b32 v1, 6, v0
    v_and_b32 v2, 63, v0
    s_nop 0
    v_readfirstlane_b32 s3, v1
    v_mov_b32 v1, v2
    v_lshlrev_b32 v2, 2, v2
    v_mov_b32 v3, 0
    ds_write_b32 v2, v3 offset:4096
    s_and_b32 s70, s2, 7
    s_lshr_b32 s71, s2, 3
    s_mov_b32 s76, 0x3db8aa3b
    s_waitcnt lgkmcnt(0)
    s_load_dword s42, s[40:41], 0
    s_mov_b32 s52, s40
    s_mov_b32 s53, s41
    s_mov_b32 s54, 33554432
    s_mov_b32 s55, 0x00020000
    s_cmp_eq_u32 s3, 0
    s_cbranch_scc1 L_ctrlA
    s_cmp_eq_u32 s3, 1
    s_cbranch_scc1 L_ctrlB
    s_sub_u32 s43, s3, 2
    s_lshl_b32 s72, s70, 24
    s_lshl_b32 s73, s71, 16
    s_add_u32 s72, s72, s73
    s_add_u32 s72, s72, 14680064
    s_add_u32 s44, s18, s72
    s_addc_u32 s45, s19, 0
    s_mov_b32 s46, 65536
    s_mov_b32 s47, 0x00020000
    s_add_u32 s48, s20, s72
    s_addc_u32 s49, s21, 0
    s_mov_b32 s50, 65536
    s_mov_b32 s51, 0x00020000
    s_mov_b32 s75, 4096
    v_and_b32 v2, 15, v1
    v_lshrrev_b32 v3, 4, v1
    s_lshl_b32 s73, s43, 13
    v_lshlrev_b32 v4, 9, v2
    v_lshl_add_u32 v4, v3, 4, v4
    v_add_u32 v4, s73, v4
    v_lshlrev_b32 v5, 9, v3
    v_lshl_add_u32 v5, v2, 4, v5
    v_add_u32 v5, s73, v5
    buffer_load_dwordx4 v[32:35], v4, s[44:47], 0 offen offset:0 nt
    buffer_load_dwordx4 v[36:39], v4, s[44:47], 0 offen offset:64 nt
    s_barrier
    buffer_load_dwordx4 v[40:43], v4, s[44:47], 0 offen offset:128 nt
    buffer_load_dwordx4 v[44:47], v4, s[44:47], 0 offen offset:192 nt
    buffer_load_dwordx4 v[48:51], v4, s[44:47], 0 offen offset:256 nt
    buffer_load_dwordx4 v[52:55], v4, s[44:47], 0 offen offset:320 nt
    s_waitcnt vmcnt(5)
    buffer_load_dwordx4 v[56:59], v4, s[44:47], 0 offen offset:384 nt
    s_waitcnt vmcnt(5)
    buffer_load_dwordx4 v[60:63], v4, s[44:47], 0 offen offset:448 nt
    s_waitcnt vmcnt(5)
    buffer_load_dwordx4 v[64:67], v5, s[48:51], 0 offen offset:0 nt
    s_waitcnt vmcnt(5)
    buffer_load_dwordx4 v[68:71], v5, s[48:51], 0 offen offset:256 nt
    s_waitcnt vmcnt(5)
    buffer_load_dwordx4 v[72:75], v5, s[48:51], 0 offen offset:2048 nt
    s_waitcnt vmcnt(5)
    buffer_load_dwordx4 v[76:79], v5, s[48:51], 0 offen offset:2304 nt
    s_waitcnt vmcnt(5)
    s_waitcnt lgkmcnt(0)
    s_mul_i32 s68, s42, 1664525
    s_add_u32 s68, s68, 1013904223
    s_xor_b32 s69, s42, 0x5bd1e995
    s_mul_i32 s69, s69, 0x9E3779B1
    s_add_u32 s69, s69, 0x7F4A7C15
    s_cmp_lg_u32 s43, 0
    s_cbranch_scc1 L_b_nok
    v_mov_b32 v6, s68
    v_mov_b32 v7, s69
    v_mov_b32 v8, 0
    ds_write_b64 v8, v[6:7] offset:4104
L_b_nok:
    buffer_load_dwordx4 v[80:83], v5, s[48:51], s75 offen offset:0 nt
    s_waitcnt vmcnt(5)
    buffer_load_dwordx4 v[84:87], v5, s[48:51], s75 offen offset:256 nt
    s_waitcnt vmcnt(5)
    buffer_load_dwordx4 v[88:91], v5, s[48:51], s75 offen offset:2048 nt
    s_waitcnt vmcnt(5)
    buffer_load_dwordx4 v[92:95], v5, s[48:51], s75 offen offset:2304 nt
    s_cmp_lg_u32 s43, 7
    s_cbranch_scc1 L_b_noi
    v_mov_b32 v6, s68
    v_mov_b32 v7, s69
    v_mov_b32 v8, 0
    ds_write_b64 v8, v[6:7] offset:4112
L_b_noi:
    v_and_b32 v10, 1, v1
    v_lshlrev_b32 v10, 4, v10
    v_mov_b32 v11, 0xffff
    v_lshlrev_b32 v11, v10, v11
    v_bfe_u32 v10, v1, 1, 2
    v_cmp_eq_u32 vcc, 0, v10
    s_nop 1
    v_cndmask_b32 v6, 0, v11, vcc
    v_cmp_eq_u32 vcc, 1, v10
    s_nop 1
    v_cndmask_b32 v7, 0, v11, vcc
    v_cmp_eq_u32 vcc, 2, v10
    s_nop 1
    v_cndmask_b32 v8, 0, v11, vcc
    v_cmp_eq_u32 vcc, 3, v10
    s_nop 1
    v_cndmask_b32 v9, 0, v11, vcc
    v_lshrrev_b32 v10, 3, v2
    v_lshlrev_b32 v10, 9, v10
    v_lshl_add_u32 v10, v3, 4, v10
    v_mov_b32 v11, 0
    s_mov_b32 s77, 0
L_b_q:
    ds_read_b64 v[12:13], v11 offset:4096
    s_waitcnt lgkmcnt(0)
    v_cmp_eq_u32 vcc, s68, v12
    v_cmp_eq_u32 s[78:79], s69, v13
    s_and_b64 vcc, vcc, s[78:79]
    s_cmp_eq_u64 vcc, -1
    s_cbranch_scc1 L_b_q_done
    s_sleep 1
    s_add_u32 s77, s77, 1
    s_cmp_lt_u32 s77, 2000000
    s_cbranch_scc1 L_b_q
L_b_q_done:
    ds_read_b32 v12, v11 offset:4120
    ds_read_b128 v[96:99], v10 offset:0
    ds_read_b128 v[100:103], v10 offset:64
    ds_read_b128 v[104:107], v10 offset:128
    ds_read_b128 v[108:111], v10 offset:192
    ds_read_b128 v[112:115], v10 offset:256
    ds_read_b128 v[116:119], v10 offset:320
    ds_read_b128 v[120:123], v10 offset:384
    ds_read_b128 v[124:127], v10 offset:448
    s_waitcnt vmcnt(8) lgkmcnt(0)
    v_readfirstlane_b32 s37, v12
    v_mfma_f32_16x16x32_bf16 v[12:15], v[32:35], v[96:99], 0
    v_mfma_f32_16x16x32_bf16 v[12:15], v[36:39], v[100:103], v[12:15]
    v_mfma_f32_16x16x32_bf16 v[12:15], v[40:43], v[104:107], v[12:15]
    v_mfma_f32_16x16x32_bf16 v[12:15], v[44:47], v[108:111], v[12:15]
    v_mfma_f32_16x16x32_bf16 v[12:15], v[48:51], v[112:115], v[12:15]
    v_mfma_f32_16x16x32_bf16 v[12:15], v[52:55], v[116:119], v[12:15]
    v_mfma_f32_16x16x32_bf16 v[12:15], v[56:59], v[120:123], v[12:15]
    v_mfma_f32_16x16x32_bf16 v[12:15], v[60:63], v[124:127], v[12:15]
    s_nop 7
    v_cvt_pk_bf16_f32 v20, v12, v13
    v_cvt_pk_bf16_f32 v21, v14, v15
    v_lshlrev_b32 v16, 16, v20
    v_and_b32 v17, 0xffff0000, v20
    v_lshlrev_b32 v18, 16, v21
    v_and_b32 v19, 0xffff0000, v21
    v_max_f32 v22, v16, v17
    v_max3_f32 v22, v18, v19, v22
    v_mov_b32 v20, v22
    s_nop 1
    v_permlane16_swap_b32 v22, v20
    v_max_f32 v22, v22, v20
    s_nop 1
    v_mov_b32 v20, v22
    s_nop 1
    v_permlane32_swap_b32 v22, v20
    v_max_f32 v22, v22, v20
    s_nop 1
    v_sub_f32 v16, v16, v22
    v_sub_f32 v17, v17, v22
    v_sub_f32 v18, v18, v22
    v_sub_f32 v19, v19, v22
    v_mul_f32 v16, s76, v16
    v_mul_f32 v17, s76, v17
    v_mul_f32 v18, s76, v18
    v_mul_f32 v19, s76, v19
    v_exp_f32 v16, v16
    v_exp_f32 v17, v17
    v_exp_f32 v18, v18
    v_exp_f32 v19, v19
    s_nop 0
    v_add_f32 v23, v16, v17
    v_add_f32 v20, v18, v19
    v_add_f32 v23, v23, v20
    v_cvt_pk_bf16_f32 v16, v16, v16
    v_cvt_pk_bf16_f32 v17, v17, v17
    v_cvt_pk_bf16_f32 v18, v18, v18
    v_cvt_pk_bf16_f32 v19, v19, v19
    v_mov_b32 v20, v23
    s_nop 1
    v_permlane16_swap_b32 v23, v20
    v_add_f32 v23, v23, v20
    s_nop 1
    v_mov_b32 v20, v23
    s_nop 1
    v_permlane32_swap_b32 v23, v20
    v_add_f32 v23, v23, v20
    s_nop 1
    v_permlane32_swap_b32 v16, v18
    v_permlane32_swap_b32 v17, v19
    s_nop 1
    v_permlane16_swap_b32 v16, v17
    v_permlane16_swap_b32 v18, v19
    v_and_b32 v96, v16, v6
    v_and_b32 v97, v16, v7
    v_and_b32 v98, v16, v8
    v_and_b32 v99, v16, v9
    v_and_b32 v100, v17, v6
    v_and_b32 v101, v17, v7
    v_and_b32 v102, v17, v8
    v_and_b32 v103, v17, v9
    v_and_b32 v104, v18, v6
    v_and_b32 v105, v18, v7
    v_and_b32 v106, v18, v8
    v_and_b32 v107, v18, v9
    v_and_b32 v108, v19, v6
    v_and_b32 v109, v19, v7
    v_and_b32 v110, v19, v8
    v_and_b32 v111, v19, v9
    v_lshrrev_b32 v20, 3, v2
    v_lshlrev_b32 v20, 3, v20
    s_lshl_b32 s73, s43, 4
    v_add_u32 v20, s73, v20
    ds_write_b64 v20, v[22:23] offset:4352
    v_lshrrev_b32 v20, 5, v1
    v_lshlrev_b32 v20, 10, v20
    v_lshl_add_u32 v20, v2, 5, v20
    v_and_b32 v21, 1, v3
    v_lshl_add_u32 v20, v21, 4, v20
    s_lshl_b32 s73, s43, 11
    v_add_u32 v20, s73, v20
    v_mov_b32 v24, s68
    v_mov_b32 v25, s69
    s_lshl_b32 s73, s43, 3
    v_mov_b32 v21, s73
    v_and_b32 v26, 7, v1
    v_lshlrev_b32 v26, 3, v26
    s_lshr_b32 s73, s43, 1
    s_lshl_b32 s73, s73, 3
    v_mov_b32 v27, s73
    v_lshrrev_b32 v28, 3, v1
    v_and_b32 v29, 3, v1
    v_lshlrev_b32 v30, 6, v28
    v_lshl_add_u32 v30, v29, 4, v30
    s_lshl_b32 s73, s43, 9
    v_add_u32 v30, s73, v30
    s_lshl_b32 s72, s70, 5
    s_lshl_b32 s73, s43, 3
    s_add_u32 s72, s72, s73
    s_mul_i32 s72, s72, 4224
    s_lshl_b32 s73, s71, 7
    s_add_u32 s72, s72, s73
    s_add_u32 s72, s72, 262144
    v_mul_u32_u24 v28, 4224, v28
    v_and_b32 v29, 7, v1
    v_lshl_add_u32 v28, v29, 4, v28
    v_add_u32 v28, s72, v28
    s_waitcnt vmcnt(7)
    v_mfma_f32_16x16x32_bf16 v[112:115], v[96:99], v[64:67], 0
    s_waitcnt vmcnt(6)
    v_mfma_f32_16x16x32_bf16 v[116:119], v[96:99], v[68:71], 0
    s_waitcnt vmcnt(5)
    v_mfma_f32_16x16x32_bf16 v[112:115], v[100:103], v[72:75], v[112:115]
    s_waitcnt vmcnt(4)
    v_mfma_f32_16x16x32_bf16 v[116:119], v[100:103], v[76:79], v[116:119]
    s_waitcnt vmcnt(3)
    v_mfma_f32_16x16x32_bf16 v[112:115], v[104:107], v[80:83], v[112:115]
    s_waitcnt vmcnt(2)
    v_mfma_f32_16x16x32_bf16 v[116:119], v[104:107], v[84:87], v[116:119]
    s_waitcnt vmcnt(1)
    v_mfma_f32_16x16x32_bf16 v[112:115], v[108:111], v[88:91], v[112:115]
    s_waitcnt vmcnt(0)
    v_mfma_f32_16x16x32_bf16 v[116:119], v[108:111], v[92:95], v[116:119]
    s_nop 6
    ds_write_b128 v20, v[112:115] offset:8192
    s_nop 0
    ds_write_b128 v20, v[116:119] offset:8704
    ds_write_b64 v21, v[24:25] offset:4160
    s_cmp_ge_u32 s43, 4
    s_cbranch_scc1 L_b_gather
    s_mov_b32 s77, 0
L_b_w:
    ds_read_b64 v[22:23], v26 offset:4160
    s_waitcnt lgkmcnt(0)
    v_cmp_eq_u32 vcc, s68, v22
    v_cmp_eq_u32 s[78:79], s69, v23
    s_and_b64 vcc, vcc, s[78:79]
    s_cmp_eq_u64 vcc, -1
    s_cbranch_scc1 L_b_w_done
    s_add_u32 s77, s77, 1
    s_cmp_lt_u32 s77, 2000000
    s_cbranch_scc1 L_b_w
L_b_w_done:
    ds_read_b64 v[32:33], v27 offset:4352
    ds_read_b64 v[34:35], v27 offset:4368
    ds_read_b64 v[36:37], v27 offset:4384
    ds_read_b64 v[38:39], v27 offset:4400
    ds_read_b64 v[40:41], v27 offset:4416
    ds_read_b64 v[42:43], v27 offset:4432
    ds_read_b64 v[44:45], v27 offset:4448
    ds_read_b64 v[46:47], v27 offset:4464
    ds_read_b128 v[48:51], v30 offset:8192
    ds_read_b128 v[52:55], v30 offset:10240
    ds_read_b128 v[56:59], v30 offset:12288
    ds_read_b128 v[60:63], v30 offset:14336
    ds_read_b128 v[64:67], v30 offset:16384
    ds_read_b128 v[68:71], v30 offset:18432
    ds_read_b128 v[72:75], v30 offset:20480
    ds_read_b128 v[76:79], v30 offset:22528
    s_waitcnt lgkmcnt(8)
    v_max3_f32 v12, v32, v34, v36
    v_max3_f32 v12, v38, v40, v12
    v_max3_f32 v12, v42, v44, v12
    v_max_f32 v12, v46, v12
    v_sub_f32 v32, v32, v12
    v_sub_f32 v34, v34, v12
    v_sub_f32 v36, v36, v12
    v_sub_f32 v38, v38, v12
    v_sub_f32 v40, v40, v12
    v_sub_f32 v42, v42, v12
    v_sub_f32 v44, v44, v12
    v_sub_f32 v46, v46, v12
    v_mul_f32 v32, s76, v32
    v_mul_f32 v34, s76, v34
    v_mul_f32 v36, s76, v36
    v_mul_f32 v38, s76, v38
    v_mul_f32 v40, s76, v40
    v_mul_f32 v42, s76, v42
    v_mul_f32 v44, s76, v44
    v_mul_f32 v46, s76, v46
    v_exp_f32 v32, v32
    v_exp_f32 v34, v34
    v_exp_f32 v36, v36
    v_exp_f32 v38, v38
    v_exp_f32 v40, v40
    v_exp_f32 v42, v42
    v_exp_f32 v44, v44
    v_exp_f32 v46, v46
    v_cmp_lt_u32 vcc, 3, v29
    v_mul_f32 v13, v32, v33
    v_fmac_f32 v13, v34, v35
    v_fmac_f32 v13, v36, v37
    v_fmac_f32 v13, v38, v39
    v_fmac_f32 v13, v40, v41
    v_fmac_f32 v13, v42, v43
    v_fmac_f32 v13, v44, v45
    v_fmac_f32 v13, v46, v47
    s_waitcnt lgkmcnt(0)
    v_mul_f32 v16, v32, v48
    v_mul_f32 v17, v32, v49
    v_mul_f32 v18, v32, v50
    v_mul_f32 v19, v32, v51
    v_fmac_f32 v16, v34, v52
    v_fmac_f32 v17, v34, v53
    v_fmac_f32 v18, v34, v54
    v_fmac_f32 v19, v34, v55
    v_fmac_f32 v16, v36, v56
    v_fmac_f32 v17, v36, v57
    v_fmac_f32 v18, v36, v58
    v_fmac_f32 v19, v36, v59
    v_fmac_f32 v16, v38, v60
    v_fmac_f32 v17, v38, v61
    v_fmac_f32 v18, v38, v62
    v_fmac_f32 v19, v38, v63
    v_fmac_f32 v16, v40, v64
    v_fmac_f32 v17, v40, v65
    v_fmac_f32 v18, v40, v66
    v_fmac_f32 v19, v40, v67
    v_fmac_f32 v16, v42, v68
    v_fmac_f32 v17, v42, v69
    v_fmac_f32 v18, v42, v70
    v_fmac_f32 v19, v42, v71
    v_fmac_f32 v16, v44, v72
    v_fmac_f32 v17, v44, v73
    v_fmac_f32 v18, v44, v74
    v_fmac_f32 v19, v44, v75
    v_fmac_f32 v16, v46, v76
    v_fmac_f32 v17, v46, v77
    v_fmac_f32 v18, v46, v78
    v_fmac_f32 v19, v46, v79
    v_cvt_pk_bf16_f32 v16, v16, v17
    v_cvt_pk_bf16_f32 v18, v18, v19
    v_mov_b32 v17, v24
    v_mov_b32 v19, v25
    v_cndmask_b32 v16, v16, v12, vcc
    v_cndmask_b32 v18, v18, v13, vcc
    s_mov_b32 s74, 4194304
    buffer_store_dwordx4 v[16:19], v28, s[52:55], 0 offen
    s_cmp_eq_u32 s37, 0
    s_cbranch_scc1 L_b_nos
    buffer_store_dwordx4 v[16:19], v28, s[52:55], s74 offen sc1
L_b_nos:
L_b_gather:
    s_cmp_ge_u32 s71, 14
    s_cbranch_scc1 L_b_end
    s_and_b32 s72, s43, 3
    s_cmp_lg_u32 s72, 0
    s_cbranch_scc1 L_b_end
    s_lshr_b32 s75, s43, 2
    s_cmp_eq_u32 s75, 0
    s_cbranch_scc1 L_b_g0
    s_cmp_eq_u32 s70, 5
    s_cbranch_scc1 L_b_end
L_b_g0:
    s_mul_i32 s72, s70, 14
    s_add_u32 s72, s72, s71
    s_mul_i32 s72, s72, 4224
    s_mul_i32 s73, s75, 524288
    s_add_u32 s72, s72, s73
    s_add_u32 s72, s72, 1572864
    v_lshl_add_u32 v20, v1, 4, s72
    s_mul_i32 s72, s75, 28672
    s_lshl_b32 s73, s71, 11
    s_add_u32 s72, s72, s73
    s_lshl_b32 s73, s70, 8
    s_add_u32 s72, s72, s73
    s_add_u32 s72, s72, 3145728
    v_and_b32 v21, 7, v1
    v_lshlrev_b32 v21, 5, v21
    v_bfe_u32 v22, v1, 3, 1
    v_lshl_add_u32 v21, v22, 4, v21
    v_add_u32 v21, s72, v21
    s_mov_b32 s77, 0
    s_cmp_lg_u32 s37, 0
    s_cselect_b32 s38, 4194304, 0
    buffer_load_dwordx4 v[32:35], v20, s[52:55], s38 offen offset:0 sc1
    buffer_load_dwordx4 v[36:39], v20, s[52:55], s38 offen offset:1024 sc1
    buffer_load_dwordx4 v[40:43], v20, s[52:55], s38 offen offset:2048 sc1
    buffer_load_dwordx4 v[44:47], v20, s[52:55], s38 offen offset:3072 sc1
    s_branch L_b_g_chk
L_b_g:
    s_cmp_ge_u32 s77, 64
    s_cselect_b32 s39, 4194304, 0
    s_xor_b32 s38, s38, s39
    s_cmp_eq_u64 s[4:5], 0
    s_cbranch_scc1 L_b_g_s0
    s_mov_b64 exec, s[4:5]
    buffer_load_dwordx4 v[32:35], v20, s[52:55], s38 offen offset:0 sc1
L_b_g_s0:
    s_cmp_eq_u64 s[6:7], 0
    s_cbranch_scc1 L_b_g_s1
    s_mov_b64 exec, s[6:7]
    buffer_load_dwordx4 v[36:39], v20, s[52:55], s38 offen offset:1024 sc1
L_b_g_s1:
    s_cmp_eq_u64 s[8:9], 0
    s_cbranch_scc1 L_b_g_s2
    s_mov_b64 exec, s[8:9]
    buffer_load_dwordx4 v[40:43], v20, s[52:55], s38 offen offset:2048 sc1
L_b_g_s2:
    s_cmp_eq_u64 s[10:11], 0
    s_cbranch_scc1 L_b_g_s3
    s_mov_b64 exec, s[10:11]
    buffer_load_dwordx4 v[44:47], v20, s[52:55], s38 offen offset:3072 sc1
L_b_g_s3:
    s_mov_b64 exec, -1
L_b_g_chk:
    s_waitcnt vmcnt(0)
    v_cmp_ne_u32 s[4:5], s68, v33
    v_cmp_ne_u32 vcc, s69, v35
    s_or_b64 s[4:5], s[4:5], vcc
    s_mov_b64 s[78:79], s[4:5]
    v_cmp_ne_u32 s[6:7], s68, v37
    v_cmp_ne_u32 vcc, s69, v39
    s_or_b64 s[6:7], s[6:7], vcc
    s_or_b64 s[78:79], s[78:79], s[6:7]
    v_cmp_ne_u32 s[8:9], s68, v41
    v_cmp_ne_u32 vcc, s69, v43
    s_or_b64 s[8:9], s[8:9], vcc
    s_or_b64 s[78:79], s[78:79], s[8:9]
    v_cmp_ne_u32 s[10:11], s68, v45
    v_cmp_ne_u32 vcc, s69, v47
    s_or_b64 s[10:11], s[10:11], vcc
    s_or_b64 s[78:79], s[78:79], s[10:11]
    s_cmp_eq_u64 s[78:79], 0
    s_cbranch_scc1 L_b_g_done
    s_sleep 1
    s_add_u32 s77, s77, 1
    s_cmp_lt_u32 s77, 200000
    s_cbranch_scc1 L_b_g
L_b_g_done:
    v_lshlrev_b32 v33, 16, v32
    v_lshlrev_b32 v35, 16, v34
    v_and_b32 v32, 0xffff0000, v32
    v_and_b32 v34, 0xffff0000, v34
    v_lshlrev_b32 v37, 16, v36
    v_lshlrev_b32 v39, 16, v38
    v_and_b32 v36, 0xffff0000, v36
    v_and_b32 v38, 0xffff0000, v38
    v_lshlrev_b32 v41, 16, v40
    v_lshlrev_b32 v43, 16, v42
    v_and_b32 v40, 0xffff0000, v40
    v_and_b32 v42, 0xffff0000, v42
    v_lshlrev_b32 v45, 16, v44
    v_lshlrev_b32 v47, 16, v46
    v_and_b32 v44, 0xffff0000, v44
    v_and_b32 v46, 0xffff0000, v46
    v_add_f32 v12, v33, v37
    v_add_f32 v16, v41, v45
    v_add_f32 v13, v32, v36
    v_add_f32 v17, v40, v44
    v_add_f32 v14, v35, v39
    v_add_f32 v18, v43, v47
    v_add_f32 v15, v34, v38
    v_add_f32 v19, v42, v46
    v_add_f32 v12, v12, v16
    v_add_f32 v13, v13, v17
    v_add_f32 v14, v14, v18
    v_add_f32 v15, v15, v19
    v_cmp_eq_u32 vcc, 1, v22
    v_add_f32_dpp v12, v12, v12 row_ror:8 row_mask:0xf bank_mask:0xf
    v_add_f32_dpp v13, v13, v13 row_ror:8 row_mask:0xf bank_mask:0xf
    v_add_f32_dpp v14, v14, v14 row_ror:8 row_mask:0xf bank_mask:0xf
    v_add_f32_dpp v15, v15, v15 row_ror:8 row_mask:0xf bank_mask:0xf
    v_mov_b32 v16, v12
    v_mov_b32 v17, v13
    v_mov_b32 v18, v14
    v_mov_b32 v19, v15
    s_nop 1
    v_permlane16_swap_b32 v12, v16
    v_permlane16_swap_b32 v13, v17
    v_permlane16_swap_b32 v14, v18
    v_permlane16_swap_b32 v15, v19
    v_add_f32 v12, v12, v16
    v_add_f32 v13, v13, v17
    v_add_f32 v14, v14, v18
    v_add_f32 v15, v15, v19
    v_mov_b32 v16, v12
    v_mov_b32 v17, v13
    v_mov_b32 v18, v14
    v_mov_b32 v19, v15
    s_nop 1
    v_permlane32_swap_b32 v12, v16
    v_permlane32_swap_b32 v13, v17
    v_permlane32_swap_b32 v14, v18
    v_permlane32_swap_b32 v15, v19
    v_add_f32 v12, v12, v16
    v_add_f32 v13, v13, v17
    v_add_f32 v14, v14, v18
    v_add_f32 v15, v15, v19
    v_cndmask_b32 v16, v12, v14, vcc
    v_mov_b32 v17, v24
    v_cndmask_b32 v18, v13, v15, vcc
    v_mov_b32 v19, v25
    s_mov_b32 exec_lo, 0xffff
    s_mov_b32 exec_hi, 0
    buffer_store_dwordx4 v[16:19], v21, s[52:55], 0 offen sc1
L_b_end:
    s_endpgm
L_ctrlA:
    s_setprio 3
    s_mov_b32 s44, s16
    s_mov_b32 s45, s17
    s_mov_b32 s46, 896
    s_mov_b32 s47, 0x00020000
    s_mov_b32 s48, s22
    s_mov_b32 s49, s23
    s_mov_b32 s50, 3670016
    s_mov_b32 s51, 0x00020000
    s_mov_b32 s56, s24
    s_mov_b32 s57, s25
    s_mov_b32 s58, 3670016
    s_mov_b32 s59, 0x00020000
    s_mov_b32 s60, s36
    s_mov_b32 s61, s37
    s_mov_b32 s62, 896
    s_mov_b32 s63, 0x00020000
    s_mov_b32 s64, s34
    s_mov_b32 s65, s35
    s_mov_b32 s66, 896
    s_mov_b32 s67, 0x00020000
    s_getreg_b32 s36, hwreg(HW_REG_XCC_ID)
    s_and_b32 s36, s36, 7
    v_lshlrev_b32 v2, 4, v1
    buffer_load_dwordx4 v[4:7], v2, s[44:47], 0 offen
    v_lshrrev_b32 v3, 2, v1
    v_lshlrev_b32 v8, 14, v3
    v_and_b32 v9, 3, v1
    v_lshl_add_u32 v8, v9, 4, v8
    s_lshl_b32 s72, s70, 10
    s_lshr_b32 s73, s71, 1
    s_lshl_b32 s73, s73, 6
    s_add_u32 s72, s72, s73
    s_and_b32 s73, s71, 1
    s_mul_i32 s73, s73, 1835008
    s_add_u32 s72, s72, s73
    v_add_u32 v8, s72, v8
    s_mov_b32 s74, 0
    buffer_load_dwordx4 v[32:35], v8, s[48:51], s74 offen nt
    s_mov_b32 s75, 8192
    buffer_load_dwordx4 v[36:39], v8, s[48:51], s75 offen nt
    s_mov_b32 s74, 262144
    buffer_load_dwordx4 v[40:43], v8, s[48:51], s74 offen nt
    s_mov_b32 s75, 270336
    buffer_load_dwordx4 v[44:47], v8, s[48:51], s75 offen nt
    s_mov_b32 s74, 524288
    buffer_load_dwordx4 v[48:51], v8, s[48:51], s74 offen nt
    s_mov_b32 s75, 532480
    buffer_load_dwordx4 v[52:55], v8, s[48:51], s75 offen nt
    s_mov_b32 s74, 786432
    buffer_load_dwordx4 v[56:59], v8, s[48:51], s74 offen nt
    s_mov_b32 s75, 794624
    buffer_load_dwordx4 v[60:63], v8, s[48:51], s75 offen nt
    s_mov_b32 s74, 1048576
    buffer_load_dwordx4 v[64:67], v8, s[48:51], s74 offen nt
    s_mov_b32 s75, 1056768
    buffer_load_dwordx4 v[68:71], v8, s[48:51], s75 offen nt
    s_mov_b32 s74, 1310720
    buffer_load_dwordx4 v[72:75], v8, s[48:51], s74 offen nt
    s_mov_b32 s75, 1318912
    buffer_load_dwordx4 v[76:79], v8, s[48:51], s75 offen nt
    s_mov_b32 s74, 1572864
    buffer_load_dwordx4 v[80:83], v8, s[48:51], s74 offen nt
    s_mov_b32 s75, 1581056
    buffer_load_dwordx4 v[84:87], v8, s[48:51], s75 offen nt
    v_and_b32 v31, 3, v1
    v_lshlrev_b32 v31, 6, v31
    v_lshrrev_b32 v30, 5, v1
    v_lshl_add_u32 v31, v30, 5, v31
    v_bfe_u32 v30, v1, 4, 1
    v_lshl_add_u32 v31, v30, 4, v31
    s_lshl_b32 s72, s70, 13
    s_and_b32 s73, s71, 1
    s_lshl_b32 s73, s73, 12
    s_add_u32 s72, s72, s73
    s_lshr_b32 s73, s71, 1
    s_lshl_b32 s73, s73, 8
    s_add_u32 s72, s72, s73
    s_add_u32 s72, s72, 65536
    v_add_u32 v31, s72, v31
    s_lshl_b32 s72, s70, 5
    s_add_u32 s72, s72, s71
    s_mul_i32 s72, s72, 4224
    s_add_u32 s72, s72, 262144
    v_add_u32 v29, s72, v2
    s_barrier
    v_cmp_gt_u32 vcc, 56, v1
    s_nop 1
    v_cndmask_b32 v9, 0, 1.0, vcc
    s_waitcnt vmcnt(14)
    v_lshlrev_b32 v10, 16, v4
    v_and_b32 v11, 0xffff0000, v4
    v_lshlrev_b32 v12, 16, v5
    v_and_b32 v13, 0xffff0000, v5
    v_lshlrev_b32 v14, 16, v6
    v_and_b32 v15, 0xffff0000, v6
    v_lshlrev_b32 v16, 16, v7
    v_and_b32 v17, 0xffff0000, v7
    v_add_f32 v18, v10, v11
    v_add_f32 v19, v12, v13
    v_add_f32 v20, v14, v15
    v_add_f32 v21, v16, v17
    v_add_f32 v18, v18, v19
    v_add_f32 v20, v20, v21
    v_add_f32 v18, v18, v20
    s_nop 1
    v_add_f32_dpp v18, v18, v18 quad_perm:[1,0,3,2] row_mask:0xf bank_mask:0xf
    s_nop 1
    v_add_f32_dpp v18, v18, v18 quad_perm:[2,3,0,1] row_mask:0xf bank_mask:0xf
    s_nop 1
    v_add_f32_dpp v18, v18, v18 row_half_mirror row_mask:0xf bank_mask:0xf
    s_nop 1
    v_add_f32_dpp v18, v18, v18 row_mirror row_mask:0xf bank_mask:0xf
    s_nop 1
    v_mov_b32 v19, v18
    s_nop 1
    v_permlane16_swap_b32 v18, v19
    v_add_f32 v18, v18, v19
    s_nop 1
    v_mov_b32 v19, v18
    s_nop 1
    v_permlane32_swap_b32 v18, v19
    v_add_f32 v18, v18, v19
    s_nop 1
    v_mul_f32 v18, 0x3b124925, v18
    v_mov_b32 v20, 0
    v_sub_f32 v19, v10, v18
    v_fmac_f32 v20, v19, v19
    v_sub_f32 v19, v11, v18
    v_fmac_f32 v20, v19, v19
    v_sub_f32 v19, v12, v18
    v_fmac_f32 v20, v19, v19
    v_sub_f32 v19, v13, v18
    v_fmac_f32 v20, v19, v19
    v_sub_f32 v19, v14, v18
    v_fmac_f32 v20, v19, v19
    v_sub_f32 v19, v15, v18
    v_fmac_f32 v20, v19, v19
    v_sub_f32 v19, v16, v18
    v_fmac_f32 v20, v19, v19
    v_sub_f32 v19, v17, v18
    v_fmac_f32 v20, v19, v19
    v_mul_f32 v20, v20, v9
    s_nop 1
    v_add_f32_dpp v20, v20, v20 quad_perm:[1,0,3,2] row_mask:0xf bank_mask:0xf
    s_nop 1
    v_add_f32_dpp v20, v20, v20 quad_perm:[2,3,0,1] row_mask:0xf bank_mask:0xf
    s_nop 1
    v_add_f32_dpp v20, v20, v20 row_half_mirror row_mask:0xf bank_mask:0xf
    s_nop 1
    v_add_f32_dpp v20, v20, v20 row_mirror row_mask:0xf bank_mask:0xf
    s_nop 1
    v_mov_b32 v19, v20
    s_nop 1
    v_permlane16_swap_b32 v20, v19
    v_add_f32 v20, v20, v19
    s_nop 1
    v_mov_b32 v19, v20
    s_nop 1
    v_permlane32_swap_b32 v20, v19
    v_add_f32 v20, v20, v19
    s_nop 1
    v_mul_f32 v20, 0x3b124925, v20
    v_cvt_pk_bf16_f32 v18, v18, v18
    v_lshlrev_b32 v18, 16, v18
    v_cvt_pk_bf16_f32 v20, v20, v20
    v_lshlrev_b32 v20, 16, v20
    v_add_f32 v20, 0x3727c5ac, v20
    v_cvt_pk_bf16_f32 v20, v20, v20
    v_lshlrev_b32 v20, 16, v20
    v_sqrt_f32 v20, v20
    s_nop 0
    v_cvt_pk_bf16_f32 v20, v20, v20
    v_lshlrev_b32 v20, 16, v20
    v_rcp_f32 v20, v20
    s_nop 0
    v_sub_f32 v10, v10, v18
    v_cvt_pk_bf16_f32 v10, v10, v10
    v_lshlrev_b32 v10, 16, v10
    v_mul_f32 v10, v10, v20
    v_cvt_pk_bf16_f32 v10, v10, v10
    v_lshlrev_b32 v10, 16, v10
    v_mul_f32 v10, v10, v9
    v_sub_f32 v11, v11, v18
    v_cvt_pk_bf16_f32 v11, v11, v11
    v_lshlrev_b32 v11, 16, v11
    v_mul_f32 v11, v11, v20
    v_cvt_pk_bf16_f32 v11, v11, v11
    v_lshlrev_b32 v11, 16, v11
    v_mul_f32 v11, v11, v9
    v_sub_f32 v12, v12, v18
    v_cvt_pk_bf16_f32 v12, v12, v12
    v_lshlrev_b32 v12, 16, v12
    v_mul_f32 v12, v12, v20
    v_cvt_pk_bf16_f32 v12, v12, v12
    v_lshlrev_b32 v12, 16, v12
    v_mul_f32 v12, v12, v9
    v_sub_f32 v13, v13, v18
    v_cvt_pk_bf16_f32 v13, v13, v13
    v_lshlrev_b32 v13, 16, v13
    v_mul_f32 v13, v13, v20
    v_cvt_pk_bf16_f32 v13, v13, v13
    v_lshlrev_b32 v13, 16, v13
    v_mul_f32 v13, v13, v9
    v_sub_f32 v14, v14, v18
    v_cvt_pk_bf16_f32 v14, v14, v14
    v_lshlrev_b32 v14, 16, v14
    v_mul_f32 v14, v14, v20
    v_cvt_pk_bf16_f32 v14, v14, v14
    v_lshlrev_b32 v14, 16, v14
    v_mul_f32 v14, v14, v9
    v_sub_f32 v15, v15, v18
    v_cvt_pk_bf16_f32 v15, v15, v15
    v_lshlrev_b32 v15, 16, v15
    v_mul_f32 v15, v15, v20
    v_cvt_pk_bf16_f32 v15, v15, v15
    v_lshlrev_b32 v15, 16, v15
    v_mul_f32 v15, v15, v9
    v_sub_f32 v16, v16, v18
    v_cvt_pk_bf16_f32 v16, v16, v16
    v_lshlrev_b32 v16, 16, v16
    v_mul_f32 v16, v16, v20
    v_cvt_pk_bf16_f32 v16, v16, v16
    v_lshlrev_b32 v16, 16, v16
    v_mul_f32 v16, v16, v9
    v_sub_f32 v17, v17, v18
    v_cvt_pk_bf16_f32 v17, v17, v17
    v_lshlrev_b32 v17, 16, v17
    v_mul_f32 v17, v17, v20
    v_cvt_pk_bf16_f32 v17, v17, v17
    v_lshlrev_b32 v17, 16, v17
    v_mul_f32 v17, v17, v9
    v_cvt_pk_bf16_f32 v4, v10, v11
    v_cvt_pk_bf16_f32 v5, v12, v13
    v_cvt_pk_bf16_f32 v6, v14, v15
    v_cvt_pk_bf16_f32 v7, v16, v17
    ds_write_b128 v2, v[4:7] offset:1024
    s_and_b32 s73, s71, 1
    s_mul_i32 s73, s73, 448
    v_lshl_add_u32 v3, v3, 2, s73
    ds_read_b32 v88, v3 offset:1024
    ds_read_b32 v89, v3 offset:1088
    ds_read_b32 v90, v3 offset:1152
    ds_read_b32 v91, v3 offset:1216
    ds_read_b32 v92, v3 offset:1280
    ds_read_b32 v93, v3 offset:1344
    ds_read_b32 v94, v3 offset:1408
    s_mov_b32 s74, 0x05040100
    s_mov_b32 s75, 0x07060302
    v_mov_b32 v104, 0
    v_mov_b32 v105, 0
    v_mov_b32 v106, 0
    v_mov_b32 v107, 0
    v_mov_b32 v108, 0
    v_mov_b32 v109, 0
    v_mov_b32 v110, 0
    v_mov_b32 v111, 0
    s_waitcnt lgkmcnt(0)
    s_mul_i32 s68, s42, 1664525
    s_add_u32 s68, s68, 1013904223
    s_xor_b32 s69, s42, 0x5bd1e995
    s_mul_i32 s69, s69, 0x9E3779B1
    s_add_u32 s69, s69, 0x7F4A7C15
    s_waitcnt vmcnt(12)
    v_perm_b32 v112, v36, v32, s74
    v_perm_b32 v113, v36, v32, s75
    v_perm_b32 v114, v37, v33, s74
    v_perm_b32 v115, v37, v33, s75
    v_perm_b32 v116, v38, v34, s74
    v_perm_b32 v117, v38, v34, s75
    v_perm_b32 v118, v39, v35, s74
    v_perm_b32 v119, v39, v35, s75
    v_dot2_f32_bf16 v104, v112, v88, v104
    v_dot2_f32_bf16 v105, v113, v88, v105
    v_dot2_f32_bf16 v106, v114, v88, v106
    v_dot2_f32_bf16 v107, v115, v88, v107
    v_dot2_f32_bf16 v108, v116, v88, v108
    v_dot2_f32_bf16 v109, v117, v88, v109
    v_dot2_f32_bf16 v110, v118, v88, v110
    v_dot2_f32_bf16 v111, v119, v88, v111
    s_nop 2
    s_waitcnt vmcnt(10)
    v_perm_b32 v112, v44, v40, s74
    v_perm_b32 v113, v44, v40, s75
    v_perm_b32 v114, v45, v41, s74
    v_perm_b32 v115, v45, v41, s75
    v_perm_b32 v116, v46, v42, s74
    v_perm_b32 v117, v46, v42, s75
    v_perm_b32 v118, v47, v43, s74
    v_perm_b32 v119, v47, v43, s75
    v_dot2_f32_bf16 v104, v112, v89, v104
    v_dot2_f32_bf16 v105, v113, v89, v105
    v_dot2_f32_bf16 v106, v114, v89, v106
    v_dot2_f32_bf16 v107, v115, v89, v107
    v_dot2_f32_bf16 v108, v116, v89, v108
    v_dot2_f32_bf16 v109, v117, v89, v109
    v_dot2_f32_bf16 v110, v118, v89, v110
    v_dot2_f32_bf16 v111, v119, v89, v111
    s_nop 2
    s_waitcnt vmcnt(8)
    v_perm_b32 v112, v52, v48, s74
    v_perm_b32 v113, v52, v48, s75
    v_perm_b32 v114, v53, v49, s74
    v_perm_b32 v115, v53, v49, s75
    v_perm_b32 v116, v54, v50, s74
    v_perm_b32 v117, v54, v50, s75
    v_perm_b32 v118, v55, v51, s74
    v_perm_b32 v119, v55, v51, s75
    v_dot2_f32_bf16 v104, v112, v90, v104
    v_dot2_f32_bf16 v105, v113, v90, v105
    v_dot2_f32_bf16 v106, v114, v90, v106
    v_dot2_f32_bf16 v107, v115, v90, v107
    v_dot2_f32_bf16 v108, v116, v90, v108
    v_dot2_f32_bf16 v109, v117, v90, v109
    v_dot2_f32_bf16 v110, v118, v90, v110
    v_dot2_f32_bf16 v111, v119, v90, v111
    s_nop 2
    s_waitcnt vmcnt(6)
    v_perm_b32 v112, v60, v56, s74
    v_perm_b32 v113, v60, v56, s75
    v_perm_b32 v114, v61, v57, s74
    v_perm_b32 v115, v61, v57, s75
    v_perm_b32 v116, v62, v58, s74
    v_perm_b32 v117, v62, v58, s75
    v_perm_b32 v118, v63, v59, s74
    v_perm_b32 v119, v63, v59, s75
    v_dot2_f32_bf16 v104, v112, v91, v104
    v_dot2_f32_bf16 v105, v113, v91, v105
    v_dot2_f32_bf16 v106, v114, v91, v106
    v_dot2_f32_bf16 v107, v115, v91, v107
    v_dot2_f32_bf16 v108, v116, v91, v108
    v_dot2_f32_bf16 v109, v117, v91, v109
    v_dot2_f32_bf16 v110, v118, v91, v110
    v_dot2_f32_bf16 v111, v119, v91, v111
    s_nop 2
    s_waitcnt vmcnt(4)
    v_perm_b32 v112, v68, v64, s74
    v_perm_b32 v113, v68, v64, s75
    v_perm_b32 v114, v69, v65, s74
    v_perm_b32 v115, v69, v65, s75
    v_perm_b32 v116, v70, v66, s74
    v_perm_b32 v117, v70, v66, s75
    v_perm_b32 v118, v71, v67, s74
    v_perm_b32 v119, v71, v67, s75
    v_dot2_f32_bf16 v104, v112, v92, v104
    v_dot2_f32_bf16 v105, v113, v92, v105
    v_dot2_f32_bf16 v106, v114, v92, v106
    v_dot2_f32_bf16 v107, v115, v92, v107
    v_dot2_f32_bf16 v108, v116, v92, v108
    v_dot2_f32_bf16 v109, v117, v92, v109
    v_dot2_f32_bf16 v110, v118, v92, v110
    v_dot2_f32_bf16 v111, v119, v92, v111
    s_nop 2
    s_waitcnt vmcnt(2)
    v_perm_b32 v112, v76, v72, s74
    v_perm_b32 v113, v76, v72, s75
    v_perm_b32 v114, v77, v73, s74
    v_perm_b32 v115, v77, v73, s75
    v_perm_b32 v116, v78, v74, s74
    v_perm_b32 v117, v78, v74, s75
    v_perm_b32 v118, v79, v75, s74
    v_perm_b32 v119, v79, v75, s75
    v_dot2_f32_bf16 v104, v112, v93, v104
    v_dot2_f32_bf16 v105, v113, v93, v105
    v_dot2_f32_bf16 v106, v114, v93, v106
    v_dot2_f32_bf16 v107, v115, v93, v107
    v_dot2_f32_bf16 v108, v116, v93, v108
    v_dot2_f32_bf16 v109, v117, v93, v109
    v_dot2_f32_bf16 v110, v118, v93, v110
    v_dot2_f32_bf16 v111, v119, v93, v111
    s_nop 2
    s_waitcnt vmcnt(0)
    v_perm_b32 v112, v84, v80, s74
    v_perm_b32 v113, v84, v80, s75
    v_perm_b32 v114, v85, v81, s74
    v_perm_b32 v115, v85, v81, s75
    v_perm_b32 v116, v86, v82, s74
    v_perm_b32 v117, v86, v82, s75
    v_perm_b32 v118, v87, v83, s74
    v_perm_b32 v119, v87, v83, s75
    v_dot2_f32_bf16 v104, v112, v94, v104
    v_dot2_f32_bf16 v105, v113, v94, v105
    v_dot2_f32_bf16 v106, v114, v94, v106
    v_dot2_f32_bf16 v107, v115, v94, v107
    v_dot2_f32_bf16 v108, v116, v94, v108
    v_dot2_f32_bf16 v109, v117, v94, v109
    v_dot2_f32_bf16 v110, v118, v94, v110
    v_dot2_f32_bf16 v111, v119, v94, v111
    s_nop 2
    s_nop 2
    v_permlane32_swap_b32 v104, v108
    v_permlane32_swap_b32 v105, v109
    v_permlane32_swap_b32 v106, v110
    v_permlane32_swap_b32 v107, v111
    v_add_f32 v104, v104, v108
    v_add_f32 v105, v105, v109
    v_add_f32 v106, v106, v110
    v_add_f32 v107, v107, v111
    s_nop 1
    v_permlane16_swap_b32 v104, v106
    v_permlane16_swap_b32 v105, v107
    v_add_f32 v104, v104, v106
    v_add_f32 v105, v105, v107
    s_nop 1
    v_add_f32_dpp v104, v104, v104 row_ror:8 row_mask:0xf bank_mask:0xf
    v_add_f32_dpp v105, v105, v105 row_ror:8 row_mask:0xf bank_mask:0xf
    s_nop 0
    v_add_f32_dpp v104, v104, v104 row_ror:4 row_mask:0xf bank_mask:0xf
    v_add_f32_dpp v105, v105, v105 row_ror:4 row_mask:0xf bank_mask:0xf
    s_nop 0
    v_mov_b32 v112, v104
    v_mov_b32 v113, s68
    v_mov_b32 v114, v105
    s_xor_b32 s36, s36, s69
    v_mov_b32 v115, s36
    s_mov_b32 exec_lo, 0x000f000f
    s_mov_b32 exec_hi, 0x000f000f
    s_waitcnt vmcnt(0)
    s_mov_b32 s74, 4194304
    buffer_store_dwordx4 v[112:115], v31, s[52:55], 0 offen
    buffer_store_dwordx4 v[112:115], v31, s[52:55], s74 offen sc1
    s_mov_b64 exec, -1
    v_mov_b32 v18, v29
    v_mov_b32 v22, 0
    s_mov_b32 s77, 0
L_a_k:
    ds_read_b64 v[20:21], v22 offset:4104
    s_waitcnt lgkmcnt(0)
    v_cmp_eq_u32 vcc, s68, v20
    v_cmp_eq_u32 s[78:79], s69, v21
    s_and_b64 vcc, vcc, s[78:79]
    s_cmp_eq_u64 vcc, -1
    s_cbranch_scc1 L_a_k_done
    s_sleep 2
    s_add_u32 s77, s77, 1
    s_cmp_lt_u32 s77, 2000000
    s_cbranch_scc1 L_a_k
L_a_k_done:
    s_lshl_b32 s72, s70, 13
    s_add_u32 s72, s72, 65536
    v_add_u32 v19, s72, v2
    v_add_u32 v20, 4096, v19
    s_mov_b32 s77, 0
    s_mov_b32 s38, 0
    buffer_load_dwordx4 v[96:99], v19, s[52:55], s38 offen offset:0 sc1
    buffer_load_dwordx4 v[100:103], v19, s[52:55], s38 offen offset:1024 sc1
    buffer_load_dwordx4 v[104:107], v19, s[52:55], s38 offen offset:2048 sc1
    buffer_load_dwordx4 v[108:111], v19, s[52:55], s38 offen offset:3072 sc1
    buffer_load_dwordx4 v[112:115], v20, s[52:55], s38 offen offset:0 sc1
    buffer_load_dwordx4 v[116:119], v20, s[52:55], s38 offen offset:1024 sc1
    buffer_load_dwordx4 v[120:123], v20, s[52:55], s38 offen offset:2048 sc1
    buffer_load_dwordx4 v[124:127], v20, s[52:55], s38 offen offset:3072 sc1
    s_branch L_a_q_chk
L_a_q:
    s_cmp_ge_u32 s77, 8
    s_cselect_b32 s39, 4194304, 0
    s_xor_b32 s38, s38, s39
    s_cmp_eq_u64 s[4:5], 0
    s_cbranch_scc1 L_a_q_s0
    s_mov_b64 exec, s[4:5]
    buffer_load_dwordx4 v[96:99], v19, s[52:55], s38 offen offset:0 sc1
L_a_q_s0:
    s_cmp_eq_u64 s[6:7], 0
    s_cbranch_scc1 L_a_q_s1
    s_mov_b64 exec, s[6:7]
    buffer_load_dwordx4 v[100:103], v19, s[52:55], s38 offen offset:1024 sc1
L_a_q_s1:
    s_cmp_eq_u64 s[8:9], 0
    s_cbranch_scc1 L_a_q_s2
    s_mov_b64 exec, s[8:9]
    buffer_load_dwordx4 v[104:107], v19, s[52:55], s38 offen offset:2048 sc1
L_a_q_s2:
    s_cmp_eq_u64 s[10:11], 0
    s_cbranch_scc1 L_a_q_s3
    s_mov_b64 exec, s[10:11]
    buffer_load_dwordx4 v[108:111], v19, s[52:55], s38 offen offset:3072 sc1
L_a_q_s3:
    s_cmp_eq_u64 s[12:13], 0
    s_cbranch_scc1 L_a_q_s4
    s_mov_b64 exec, s[12:13]
    buffer_load_dwordx4 v[112:115], v20, s[52:55], s38 offen offset:0 sc1
L_a_q_s4:
    s_cmp_eq_u64 s[14:15], 0
    s_cbranch_scc1 L_a_q_s5
    s_mov_b64 exec, s[14:15]
    buffer_load_dwordx4 v[116:119], v20, s[52:55], s38 offen offset:1024 sc1
L_a_q_s5:
    s_cmp_eq_u64 s[16:17], 0
    s_cbranch_scc1 L_a_q_s6
    s_mov_b64 exec, s[16:17]
    buffer_load_dwordx4 v[120:123], v20, s[52:55], s38 offen offset:2048 sc1
L_a_q_s6:
    s_cmp_eq_u64 s[18:19], 0
    s_cbranch_scc1 L_a_q_s7
    s_mov_b64 exec, s[18:19]
    buffer_load_dwordx4 v[124:127], v20, s[52:55], s38 offen offset:3072 sc1
L_a_q_s7:
    s_mov_b64 exec, -1
L_a_q_chk:
    s_waitcnt vmcnt(0)
    v_cmp_ne_u32 s[4:5], s68, v97
    v_xor_b32 v21, s69, v99
    v_cmp_le_u32 vcc, 8, v21
    s_or_b64 s[4:5], s[4:5], vcc
    s_mov_b64 s[78:79], s[4:5]
    v_cmp_ne_u32 s[6:7], s68, v101
    v_xor_b32 v21, s69, v103
    v_cmp_le_u32 vcc, 8, v21
    s_or_b64 s[6:7], s[6:7], vcc
    s_or_b64 s[78:79], s[78:79], s[6:7]
    v_cmp_ne_u32 s[8:9], s68, v105
    v_xor_b32 v21, s69, v107
    v_cmp_le_u32 vcc, 8, v21
    s_or_b64 s[8:9], s[8:9], vcc
    s_or_b64 s[78:79], s[78:79], s[8:9]
    v_cmp_ne_u32 s[10:11], s68, v109
    v_xor_b32 v21, s69, v111
    v_cmp_le_u32 vcc, 8, v21
    s_or_b64 s[10:11], s[10:11], vcc
    s_or_b64 s[78:79], s[78:79], s[10:11]
    v_cmp_ne_u32 s[12:13], s68, v113
    v_xor_b32 v21, s69, v115
    v_cmp_le_u32 vcc, 8, v21
    s_or_b64 s[12:13], s[12:13], vcc
    s_or_b64 s[78:79], s[78:79], s[12:13]
    v_cmp_ne_u32 s[14:15], s68, v117
    v_xor_b32 v21, s69, v119
    v_cmp_le_u32 vcc, 8, v21
    s_or_b64 s[14:15], s[14:15], vcc
    s_or_b64 s[78:79], s[78:79], s[14:15]
    v_cmp_ne_u32 s[16:17], s68, v121
    v_xor_b32 v21, s69, v123
    v_cmp_le_u32 vcc, 8, v21
    s_or_b64 s[16:17], s[16:17], vcc
    s_or_b64 s[78:79], s[78:79], s[16:17]
    v_cmp_ne_u32 s[18:19], s68, v125
    v_xor_b32 v21, s69, v127
    v_cmp_le_u32 vcc, 8, v21
    s_or_b64 s[18:19], s[18:19], vcc
    s_or_b64 s[78:79], s[78:79], s[18:19]
    s_cmp_eq_u64 s[78:79], 0
    s_cbranch_scc1 L_a_q_done
    s_add_u32 s77, s77, 1
    s_cmp_lt_u32 s77, 200000
    s_cbranch_scc1 L_a_q
L_a_q_done:
    v_cmp_ne_u32 s[4:5], s36, v99
    v_cmp_ne_u32 s[6:7], s36, v103
    v_cmp_ne_u32 s[8:9], s36, v107
    v_cmp_ne_u32 s[10:11], s36, v111
    v_cmp_ne_u32 s[12:13], s36, v115
    v_cmp_ne_u32 s[14:15], s36, v119
    v_cmp_ne_u32 s[16:17], s36, v123
    v_cmp_ne_u32 s[18:19], s36, v127
    s_or_b64 s[4:5], s[4:5], s[6:7]
    s_or_b64 s[4:5], s[4:5], s[8:9]
    s_or_b64 s[4:5], s[4:5], s[10:11]
    s_or_b64 s[4:5], s[4:5], s[12:13]
    s_or_b64 s[4:5], s[4:5], s[14:15]
    s_or_b64 s[4:5], s[4:5], s[16:17]
    s_or_b64 s[4:5], s[4:5], s[18:19]
    s_or_b32 s37, s4, s5
    v_mov_b32 v23, s37
    v_add_f32 v96, v96, v112
    v_add_f32 v98, v98, v114
    v_add_f32 v100, v100, v116
    v_add_f32 v102, v102, v118
    v_add_f32 v104, v104, v120
    v_add_f32 v106, v106, v122
    v_add_f32 v108, v108, v124
    v_add_f32 v110, v110, v126
    v_cvt_pk_bf16_f32 v96, v96, v98
    v_cvt_pk_bf16_f32 v100, v100, v102
    v_cvt_pk_bf16_f32 v104, v104, v106
    v_cvt_pk_bf16_f32 v108, v108, v110
    v_lshlrev_b32 v19, 2, v1
    v_mov_b32 v20, s68
    v_mov_b32 v21, s69
    v_mov_b32 v22, 0
    ds_write_b32 v19, v96 offset:0
    ds_write_b32 v19, v100 offset:256
    ds_write_b32 v19, v104 offset:512
    ds_write_b32 v19, v108 offset:768
    ds_write_b32 v22, v23 offset:4120
    ds_write_b64 v22, v[20:21] offset:4096
    s_cmp_lg_u32 s70, 0
    s_cbranch_scc1 L_a_np2
    s_cmp_ge_u32 s71, 14
    s_cbranch_scc1 L_a_np2
    s_lshl_b32 s72, s71, 11
    s_add_u32 s72, s72, 3145728
    v_add_u32 v19, s72, v2
    s_movk_i32 s72, 28672
    buffer_load_dwordx4 v[96:99], v19, s[52:55], 0 offen sc1
    buffer_load_dwordx4 v[96:99], v19, s[52:55], 0 offen offset:1024 sc1
    buffer_load_dwordx4 v[96:99], v19, s[52:55], s72 offen sc1
    buffer_load_dwordx4 v[96:99], v19, s[52:55], s72 offen offset:1024 sc1
L_a_np2:
    v_and_b32 v23, 15, v1
    v_lshrrev_b32 v24, 4, v1
    s_movk_i32 s74, 896
    v_mul_lo_u32 v25, v24, s74
    v_lshl_add_u32 v25, v23, 4, v25
    s_lshl_b32 s72, s70, 5
    s_add_u32 s72, s72, s71
    s_mul_i32 s72, s72, 14336
    v_add_u32 v25, s72, v25
    s_mov_b32 s77, 0
L_a_i:
    ds_read_b64 v[20:21], v22 offset:4112
    s_waitcnt lgkmcnt(0)
    v_cmp_eq_u32 vcc, s68, v20
    v_cmp_eq_u32 s[78:79], s69, v21
    s_and_b64 vcc, vcc, s[78:79]
    s_cmp_eq_u64 vcc, -1
    s_cbranch_scc1 L_a_i_done
    s_sleep 2
    s_add_u32 s77, s77, 1
    s_cmp_lt_u32 s77, 2000000
    s_cbranch_scc1 L_a_i
L_a_i_done:
    s_mov_b32 s74, 0
    buffer_load_dwordx4 v[32:35], v25, s[56:59], s74 offen offset:0 nt
    buffer_load_dwordx4 v[36:39], v25, s[56:59], s74 offen offset:256 nt
    buffer_load_dwordx4 v[40:43], v25, s[56:59], s74 offen offset:512 nt
    buffer_load_dwordx4 v[44:47], v25, s[56:59], s74 offen offset:768 nt
    s_mov_b32 s75, 3584
    buffer_load_dwordx4 v[48:51], v25, s[56:59], s75 offen offset:0 nt
    buffer_load_dwordx4 v[52:55], v25, s[56:59], s75 offen offset:256 nt
    buffer_load_dwordx4 v[56:59], v25, s[56:59], s75 offen offset:512 nt
    buffer_load_dwordx4 v[60:63], v25, s[56:59], s75 offen offset:768 nt
    s_mov_b32 s74, 7168
    buffer_load_dwordx4 v[64:67], v25, s[56:59], s74 offen offset:0 nt
    buffer_load_dwordx4 v[68:71], v25, s[56:59], s74 offen offset:256 nt
    buffer_load_dwordx4 v[72:75], v25, s[56:59], s74 offen offset:512 nt
    buffer_load_dwordx4 v[76:79], v25, s[56:59], s74 offen offset:768 nt
    s_mov_b32 s75, 10752
    buffer_load_dwordx4 v[80:83], v25, s[56:59], s75 offen offset:0 nt
    buffer_load_dwordx4 v[84:87], v25, s[56:59], s75 offen offset:256 nt
    buffer_load_dwordx4 v[88:91], v25, s[56:59], s75 offen offset:512 nt
    buffer_load_dwordx4 v[92:95], v25, s[56:59], s75 offen offset:768 nt
    s_lshl_b32 s72, s71, 6
    v_and_b32 v26, 15, v1
    v_lshl_add_u32 v26, v26, 2, s72
    buffer_load_dword v27, v26, s[44:47], 0 offen
    buffer_load_dword v28, v26, s[64:67], 0 offen
    v_and_b32 v14, 1, v1
    v_lshlrev_b32 v14, 4, v14
    v_mov_b32 v15, 0xffff
    v_lshlrev_b32 v15, v14, v15
    v_bfe_u32 v14, v1, 1, 3
    v_cmp_eq_u32 vcc, 0, v14
    s_nop 1
    v_cndmask_b32 v10, 0, v15, vcc
    v_cmp_eq_u32 vcc, 1, v14
    s_nop 1
    v_cndmask_b32 v11, 0, v15, vcc
    v_cmp_eq_u32 vcc, 2, v14
    s_nop 1
    v_cndmask_b32 v12, 0, v15, vcc
    v_cmp_eq_u32 vcc, 3, v14
    s_nop 1
    v_cndmask_b32 v13, 0, v15, vcc
    v_lshrrev_b32 v30, 1, v24
    v_cmp_eq_u32 vcc, 1, v30
    v_mov_b32 v14, 0
    v_mov_b32 v31, 28
    v_cndmask_b32 v14, v14, v31, vcc
    v_mov_b32 v15, 4
    v_mov_b32 v31, 24
    v_cndmask_b32 v15, v15, v31, vcc
    v_mov_b32 v16, 8
    v_mov_b32 v31, 20
    v_cndmask_b32 v16, v16, v31, vcc
    v_mov_b32 v17, 12
    v_mov_b32 v31, 16
    v_cndmask_b32 v17, v17, v31, vcc
    v_and_b32 v29, 1, v24
    v_cmp_eq_u32 vcc, 1, v29
    v_mov_b32 v29, 0x01000100
    v_mov_b32 v31, 0x03020302
    v_cndmask_b32 v29, v29, v31, vcc
    v_bfe_u32 v30, v1, 2, 2
    v_lshrrev_b32 v31, 5, v1
    v_lshl_add_u32 v30, v31, 2, v30
    v_mul_u32_u24 v30, 4224, v30
    v_and_b32 v31, 3, v1
    v_lshl_add_u32 v30, v31, 5, v30
    v_bfe_u32 v31, v1, 4, 1
    v_lshl_add_u32 v30, v31, 4, v30
    s_mul_i32 s72, s70, 59136
    s_lshl_b32 s73, s71, 7
    s_add_u32 s72, s72, s73
    s_add_u32 s72, s72, 1572864
    v_add_u32 v30, s72, v30
    v_and_b32 v20, 7, v1
    v_lshlrev_b32 v20, 3, v20
    s_waitcnt vmcnt(0)
    s_mov_b32 s77, 0
L_a_w:
    ds_read_b64 v[22:23], v20 offset:4160
    s_waitcnt lgkmcnt(0)
    v_cmp_eq_u32 vcc, s68, v22
    v_cmp_eq_u32 s[78:79], s69, v23
    s_and_b64 vcc, vcc, s[78:79]
    s_cmp_eq_u64 vcc, -1
    s_cbranch_scc1 L_a_w_done
    s_sleep 2
    s_add_u32 s77, s77, 1
    s_cmp_lt_u32 s77, 2000000
    s_cbranch_scc1 L_a_w
L_a_w_done:
    s_mov_b32 s77, 0
    s_cmp_lg_u32 s37, 0
    s_cselect_b32 s38, 4194304, 0
    buffer_load_dwordx4 v[96:99], v18, s[52:55], s38 offen offset:0 sc1
    buffer_load_dwordx4 v[100:103], v18, s[52:55], s38 offen offset:1024 sc1
    buffer_load_dwordx4 v[104:107], v18, s[52:55], s38 offen offset:2048 sc1
    buffer_load_dwordx4 v[108:111], v18, s[52:55], s38 offen offset:3072 sc1
    s_branch L_a_o_chk
L_a_o:
    s_cmp_ge_u32 s77, 64
    s_cselect_b32 s39, 4194304, 0
    s_xor_b32 s38, s38, s39
    s_cmp_eq_u64 s[4:5], 0
    s_cbranch_scc1 L_a_o_s0
    s_mov_b64 exec, s[4:5]
    buffer_load_dwordx4 v[96:99], v18, s[52:55], s38 offen offset:0 sc1
L_a_o_s0:
    s_cmp_eq_u64 s[6:7], 0
    s_cbranch_scc1 L_a_o_s1
    s_mov_b64 exec, s[6:7]
    buffer_load_dwordx4 v[100:103], v18, s[52:55], s38 offen offset:1024 sc1
L_a_o_s1:
    s_cmp_eq_u64 s[8:9], 0
    s_cbranch_scc1 L_a_o_s2
    s_mov_b64 exec, s[8:9]
    buffer_load_dwordx4 v[104:107], v18, s[52:55], s38 offen offset:2048 sc1
L_a_o_s2:
    s_cmp_eq_u64 s[10:11], 0
    s_cbranch_scc1 L_a_o_s3
    s_mov_b64 exec, s[10:11]
    buffer_load_dwordx4 v[108:111], v18, s[52:55], s38 offen offset:3072 sc1
L_a_o_s3:
    s_mov_b64 exec, -1
L_a_o_chk:
    s_waitcnt vmcnt(0)
    v_cmp_ne_u32 s[4:5], s68, v97
    v_cmp_ne_u32 vcc, s69, v99
    s_or_b64 s[4:5], s[4:5], vcc
    s_mov_b64 s[78:79], s[4:5]
    v_cmp_ne_u32 s[6:7], s68, v101
    v_cmp_ne_u32 vcc, s69, v103
    s_or_b64 s[6:7], s[6:7], vcc
    s_or_b64 s[78:79], s[78:79], s[6:7]
    v_cmp_ne_u32 s[8:9], s68, v105
    v_cmp_ne_u32 vcc, s69, v107
    s_or_b64 s[8:9], s[8:9], vcc
    s_or_b64 s[78:79], s[78:79], s[8:9]
    v_cmp_ne_u32 s[10:11], s68, v109
    v_cmp_ne_u32 vcc, s69, v111
    s_or_b64 s[10:11], s[10:11], vcc
    s_or_b64 s[78:79], s[78:79], s[10:11]
    s_cmp_eq_u64 s[78:79], 0
    s_cbranch_scc1 L_a_o_done
    s_sleep 1
    s_add_u32 s77, s77, 1
    s_cmp_lt_u32 s77, 200000
    s_cbranch_scc1 L_a_o
L_a_o_done:
    v_mov_b32 v97, v96
    v_mov_b32 v99, v98
    v_mov_b32 v101, v100
    v_mov_b32 v103, v102
    v_mov_b32 v105, v104
    v_mov_b32 v107, v106
    v_mov_b32 v109, v108
    v_mov_b32 v111, v110
    v_mov_b32_dpp v97, v96 row_half_mirror row_mask:0xf bank_mask:0x5
    v_mov_b32_dpp v99, v98 row_half_mirror row_mask:0xf bank_mask:0x5
    v_mov_b32_dpp v101, v100 row_half_mirror row_mask:0xf bank_mask:0x5
    v_mov_b32_dpp v103, v102 row_half_mirror row_mask:0xf bank_mask:0x5
    v_mov_b32_dpp v105, v104 row_half_mirror row_mask:0xf bank_mask:0x5
    v_mov_b32_dpp v107, v106 row_half_mirror row_mask:0xf bank_mask:0x5
    v_mov_b32_dpp v109, v108 row_half_mirror row_mask:0xf bank_mask:0x5
    v_mov_b32_dpp v111, v110 row_half_mirror row_mask:0xf bank_mask:0x5
    v_max3_f32 v20, v97, v101, v105
    v_max_f32 v20, v109, v20
    v_lshlrev_b32 v112, 16, v96
    v_and_b32 v113, 0xffff0000, v96
    v_lshlrev_b32 v114, 16, v98
    v_and_b32 v115, 0xffff0000, v98
    v_lshlrev_b32 v116, 16, v100
    v_and_b32 v117, 0xffff0000, v100
    v_lshlrev_b32 v118, 16, v102
    v_and_b32 v119, 0xffff0000, v102
    v_lshlrev_b32 v120, 16, v104
    v_and_b32 v121, 0xffff0000, v104
    v_lshlrev_b32 v122, 16, v106
    v_and_b32 v123, 0xffff0000, v106
    v_lshlrev_b32 v124, 16, v108
    v_and_b32 v125, 0xffff0000, v108
    v_lshlrev_b32 v126, 16, v110
    v_and_b32 v127, 0xffff0000, v110
    v_max_f32_dpp v20, v20, v20 row_ror:8 row_mask:0xf bank_mask:0xf
    s_nop 1
    v_mov_b32 v21, v20
    s_nop 1
    v_permlane16_swap_b32 v20, v21
    v_max_f32 v20, v20, v21
    s_nop 1
    v_mov_b32 v21, v20
    s_nop 1
    v_permlane32_swap_b32 v20, v21
    v_max_f32 v20, v20, v21
    s_nop 1
    v_sub_f32 v97, v97, v20
    v_sub_f32 v101, v101, v20
    v_sub_f32 v105, v105, v20
    v_sub_f32 v109, v109, v20
    v_mul_f32 v97, s76, v97
    v_mul_f32 v101, s76, v101
    v_mul_f32 v105, s76, v105
    v_mul_f32 v109, s76, v109
    v_exp_f32 v97, v97
    v_exp_f32 v101, v101
    v_exp_f32 v105, v105
    v_exp_f32 v109, v109
    s_nop 0
    v_mul_f32 v20, v97, v99
    v_mul_f32 v21, v97, v112
    v_mul_f32 v22, v97, v113
    v_mul_f32 v23, v97, v114
    v_mul_f32 v24, v97, v115
    v_fmac_f32 v20, v101, v103
    v_fmac_f32 v21, v101, v116
    v_fmac_f32 v22, v101, v117
    v_fmac_f32 v23, v101, v118
    v_fmac_f32 v24, v101, v119
    v_fmac_f32 v20, v105, v107
    v_fmac_f32 v21, v105, v120
    v_fmac_f32 v22, v105, v121
    v_fmac_f32 v23, v105, v122
    v_fmac_f32 v24, v105, v123
    v_fmac_f32 v20, v109, v111
    v_fmac_f32 v21, v109, v124
    v_fmac_f32 v22, v109, v125
    v_fmac_f32 v23, v109, v126
    v_fmac_f32 v24, v109, v127
    v_add_f32_dpp v20, v20, v20 row_ror:8 row_mask:0xf bank_mask:0xf
    v_add_f32_dpp v21, v21, v21 row_ror:8 row_mask:0xf bank_mask:0xf
    v_add_f32_dpp v22, v22, v22 row_ror:8 row_mask:0xf bank_mask:0xf
    v_add_f32_dpp v23, v23, v23 row_ror:8 row_mask:0xf bank_mask:0xf
    v_add_f32_dpp v24, v24, v24 row_ror:8 row_mask:0xf bank_mask:0xf
    v_mov_b32 v112, v20
    v_mov_b32 v113, v21
    v_mov_b32 v114, v22
    v_mov_b32 v115, v23
    v_mov_b32 v116, v24
    s_nop 1
    v_permlane16_swap_b32 v20, v112
    v_permlane16_swap_b32 v21, v113
    v_permlane16_swap_b32 v22, v114
    v_permlane16_swap_b32 v23, v115
    v_permlane16_swap_b32 v24, v116
    v_add_f32 v20, v20, v112
    v_add_f32 v21, v21, v113
    v_add_f32 v22, v22, v114
    v_add_f32 v23, v23, v115
    v_add_f32 v24, v24, v116
    v_mov_b32 v112, v20
    v_mov_b32 v113, v21
    v_mov_b32 v114, v22
    v_mov_b32 v115, v23
    v_mov_b32 v116, v24
    s_nop 1
    v_permlane32_swap_b32 v20, v112
    v_permlane32_swap_b32 v21, v113
    v_permlane32_swap_b32 v22, v114
    v_permlane32_swap_b32 v23, v115
    v_permlane32_swap_b32 v24, v116
    v_add_f32 v20, v20, v112
    v_add_f32 v21, v21, v113
    v_add_f32 v22, v22, v114
    v_add_f32 v23, v23, v115
    v_add_f32 v24, v24, v116
    v_rcp_f32 v20, v20
    s_nop 0
    v_mul_f32 v21, v21, v20
    v_mul_f32 v22, v22, v20
    v_mul_f32 v23, v23, v20
    v_mul_f32 v24, v24, v20
    v_cvt_pk_bf16_f32 v21, v21, v22
    v_cvt_pk_bf16_f32 v23, v23, v24
    s_nop 1
    v_mov_b32_dpp v21, v23 row_half_mirror row_mask:0xf bank_mask:0xa
    s_nop 0
    ds_bpermute_b32 v96, v14, v21
    ds_bpermute_b32 v97, v15, v21
    ds_bpermute_b32 v98, v16, v21
    ds_bpermute_b32 v99, v17, v21
    s_waitcnt lgkmcnt(0)
    v_perm_b32 v96, v96, v96, v29
    v_perm_b32 v97, v97, v97, v29
    v_perm_b32 v98, v98, v98, v29
    v_perm_b32 v99, v99, v99, v29
    v_and_b32 v100, v96, v10
    v_and_b32 v101, v96, v11
    v_and_b32 v102, v96, v12
    v_and_b32 v103, v96, v13
    v_and_b32 v104, v97, v10
    v_and_b32 v105, v97, v11
    v_and_b32 v106, v97, v12
    v_and_b32 v107, v97, v13
    v_and_b32 v108, v98, v10
    v_and_b32 v109, v98, v11
    v_and_b32 v110, v98, v12
    v_and_b32 v111, v98, v13
    v_and_b32 v112, v99, v10
    v_and_b32 v113, v99, v11
    v_and_b32 v114, v99, v12
    v_and_b32 v115, v99, v13
    s_nop 1
    v_mfma_f32_16x16x32_bf16 v[116:119], v[100:103], v[32:35], 0
    v_mfma_f32_16x16x32_bf16 v[120:123], v[100:103], v[36:39], 0
    v_mfma_f32_16x16x32_bf16 v[124:127], v[100:103], v[40:43], 0
    v_mfma_f32_16x16x32_bf16 v[4:7], v[100:103], v[44:47], 0
    v_mfma_f32_16x16x32_bf16 v[116:119], v[104:107], v[48:51], v[116:119]
    v_mfma_f32_16x16x32_bf16 v[120:123], v[104:107], v[52:55], v[120:123]
    v_mfma_f32_16x16x32_bf16 v[124:127], v[104:107], v[56:59], v[124:127]
    v_mfma_f32_16x16x32_bf16 v[4:7], v[104:107], v[60:63], v[4:7]
    v_mfma_f32_16x16x32_bf16 v[116:119], v[108:111], v[64:67], v[116:119]
    v_mfma_f32_16x16x32_bf16 v[120:123], v[108:111], v[68:71], v[120:123]
    v_mfma_f32_16x16x32_bf16 v[124:127], v[108:111], v[72:75], v[124:127]
    v_mfma_f32_16x16x32_bf16 v[4:7], v[108:111], v[76:79], v[4:7]
    v_mfma_f32_16x16x32_bf16 v[116:119], v[112:115], v[80:83], v[116:119]
    v_mfma_f32_16x16x32_bf16 v[120:123], v[112:115], v[84:87], v[120:123]
    v_mfma_f32_16x16x32_bf16 v[124:127], v[112:115], v[88:91], v[124:127]
    v_mfma_f32_16x16x32_bf16 v[4:7], v[112:115], v[92:95], v[4:7]
    s_nop 7
    v_cvt_pk_bf16_f32 v96, v116, v117
    v_cvt_pk_bf16_f32 v98, v118, v119
    v_cvt_pk_bf16_f32 v120, v120, v121
    v_cvt_pk_bf16_f32 v122, v122, v123
    v_mov_b32 v97, s68
    v_mov_b32 v99, s69
    v_cvt_pk_bf16_f32 v100, v124, v125
    v_cvt_pk_bf16_f32 v102, v126, v127
    v_cvt_pk_bf16_f32 v4, v4, v5
    v_cvt_pk_bf16_f32 v6, v6, v7
    v_mov_b32 v101, s68
    v_mov_b32 v103, s69
    s_mov_b32 s74, 33792
    v_permlane32_swap_b32 v96, v120
    v_permlane32_swap_b32 v98, v122
    v_permlane32_swap_b32 v100, v4
    v_permlane32_swap_b32 v102, v6
    buffer_store_dwordx4 v[96:99], v30, s[52:55], 0 offen
    s_mov_b32 exec_hi, 0x00ff00ff
    buffer_store_dwordx4 v[100:103], v30, s[52:55], s74 offen
    s_cmp_eq_u32 s37, 0
    s_cbranch_scc1 L_a_nos
    s_mov_b32 s74, 4228096
    s_mov_b32 s75, 4194304
    buffer_store_dwordx4 v[100:103], v30, s[52:55], s74 offen sc1
    s_mov_b64 exec, -1
    buffer_store_dwordx4 v[96:99], v30, s[52:55], s75 offen sc1
L_a_nos:
    s_mov_b64 exec, -1
    s_cmp_lg_u32 s70, 0
    s_cbranch_scc1 L_a_end
    s_cmp_ge_u32 s71, 14
    s_cbranch_scc1 L_a_end
    s_lshl_b32 s72, s71, 11
    s_add_u32 s72, s72, 3145728
    v_add_u32 v18, s72, v2
    v_add_u32 v19, 28672, v18
    s_mov_b32 s77, 0
    buffer_load_dwordx4 v[32:35], v18, s[52:55], 0 offen sc1
    buffer_load_dwordx4 v[36:39], v18, s[52:55], 0 offen offset:1024 sc1
    buffer_load_dwordx4 v[40:43], v19, s[52:55], 0 offen sc1
    buffer_load_dwordx4 v[44:47], v19, s[52:55], 0 offen offset:1024 sc1
    s_branch L_a_f_chk
L_a_f:
    s_cmp_eq_u64 s[4:5], 0
    s_cbranch_scc1 L_a_f_s0
    s_mov_b64 exec, s[4:5]
    buffer_load_dwordx4 v[32:35], v18, s[52:55], 0 offen sc1
L_a_f_s0:
    s_cmp_eq_u64 s[6:7], 0
    s_cbranch_scc1 L_a_f_s1
    s_mov_b64 exec, s[6:7]
    buffer_load_dwordx4 v[36:39], v18, s[52:55], 0 offen offset:1024 sc1
L_a_f_s1:
    s_cmp_eq_u64 s[8:9], 0
    s_cbranch_scc1 L_a_f_s2
    s_mov_b64 exec, s[8:9]
    buffer_load_dwordx4 v[40:43], v19, s[52:55], 0 offen sc1
L_a_f_s2:
    s_cmp_eq_u64 s[10:11], 0
    s_cbranch_scc1 L_a_f_s3
    s_mov_b64 exec, s[10:11]
    buffer_load_dwordx4 v[44:47], v19, s[52:55], 0 offen offset:1024 sc1
L_a_f_s3:
    s_mov_b64 exec, -1
L_a_f_chk:
    s_waitcnt vmcnt(0)
    v_cmp_ne_u32 s[4:5], s68, v33
    v_cmp_ne_u32 vcc, s69, v35
    s_or_b64 s[4:5], s[4:5], vcc
    s_mov_b64 s[78:79], s[4:5]
    v_cmp_ne_u32 s[6:7], s68, v37
    v_cmp_ne_u32 vcc, s69, v39
    s_or_b64 s[6:7], s[6:7], vcc
    s_or_b64 s[78:79], s[78:79], s[6:7]
    v_cmp_ne_u32 s[8:9], s68, v41
    v_cmp_ne_u32 vcc, s69, v43
    s_or_b64 s[8:9], s[8:9], vcc
    s_or_b64 s[78:79], s[78:79], s[8:9]
    v_cmp_ne_u32 s[10:11], s68, v45
    v_cmp_ne_u32 vcc, s69, v47
    s_or_b64 s[10:11], s[10:11], vcc
    s_and_b32 s10, s10, 0xffff
    s_and_b32 s11, s11, 0xffffffff
    s_or_b64 s[78:79], s[78:79], s[10:11]
    s_cmp_eq_u64 s[78:79], 0
    s_cbranch_scc1 L_a_f_done
    s_sleep 1
    s_add_u32 s77, s77, 1
    s_cmp_lt_u32 s77, 200000
    s_cbranch_scc1 L_a_f
L_a_f_done:
    s_mov_b32 exec_lo, 0xffff0000
    s_mov_b32 exec_hi, 0x0
    v_mov_b32 v44, 0
    v_mov_b32 v46, 0
    s_mov_b64 exec, -1
    v_add_f32 v20, v32, v36
    v_add_f32 v21, v34, v38
    v_add_f32 v18, v40, v44
    v_add_f32 v19, v42, v46
    v_lshlrev_b32 v22, 16, v27
    v_and_b32 v23, 0xffff0000, v27
    v_lshlrev_b32 v24, 16, v28
    v_and_b32 v25, 0xffff0000, v28
    v_mov_b32 v32, v20
    v_mov_b32 v33, v21
    v_mov_b32 v34, v18
    v_mov_b32 v35, v19
    s_nop 1
    v_permlane16_swap_b32 v20, v32
    v_permlane16_swap_b32 v21, v33
    v_permlane16_swap_b32 v18, v34
    v_permlane16_swap_b32 v19, v35
    v_add_f32 v20, v20, v32
    v_add_f32 v21, v21, v33
    v_add_f32 v18, v18, v34
    v_add_f32 v19, v19, v35
    v_mov_b32 v32, v20
    v_mov_b32 v33, v21
    v_mov_b32 v34, v18
    v_mov_b32 v35, v19
    s_nop 1
    v_permlane32_swap_b32 v20, v32
    v_permlane32_swap_b32 v21, v33
    v_permlane32_swap_b32 v18, v34
    v_permlane32_swap_b32 v19, v35
    v_add_f32 v20, v20, v32
    v_add_f32 v21, v21, v33
    v_add_f32 v18, v18, v34
    v_add_f32 v19, v19, v35
    v_cvt_pk_bf16_f32 v20, v20, v20
    v_lshlrev_b32 v20, 16, v20
    v_cvt_pk_bf16_f32 v18, v18, v18
    v_lshlrev_b32 v18, 16, v18
    v_cvt_pk_bf16_f32 v21, v21, v21
    v_lshlrev_b32 v21, 16, v21
    v_cvt_pk_bf16_f32 v19, v19, v19
    v_lshlrev_b32 v19, 16, v19
    v_add_f32 v20, v20, v22
    v_add_f32 v18, v18, v24
    v_add_f32 v21, v21, v23
    v_add_f32 v19, v19, v25
    v_cvt_pk_bf16_f32 v20, v20, v20
    v_lshlrev_b32 v20, 16, v20
    v_cvt_pk_bf16_f32 v18, v18, v18
    v_lshlrev_b32 v18, 16, v18
    v_cvt_pk_bf16_f32 v21, v21, v21
    v_lshlrev_b32 v21, 16, v21
    v_cvt_pk_bf16_f32 v19, v19, v19
    v_lshlrev_b32 v19, 16, v19
    v_add_f32 v20, v20, v18
    v_add_f32 v21, v21, v19
    v_cvt_pk_bf16_f32 v20, v20, v21
    s_mov_b32 exec_lo, 0xffff
    s_mov_b32 exec_hi, 0
    buffer_store_dword v20, v26, s[60:63], 0 offen
    s_cmp_lg_u32 s2, 0
    s_cbranch_scc1 L_a_end
    s_mov_b32 exec_lo, 1
    v_mov_b32 v21, s68
    v_mov_b32 v22, 0
    buffer_store_dword v21, v22, s[52:55], 0 offen sc1
L_a_end:
    s_endpgm
L_ctrlB:
    s_cmp_eq_u32 s70, 5
    s_cbranch_scc1 L_end
    s_cmp_gt_u32 s70, 5
    s_cselect_b32 s72, 1, 0
    s_sub_u32 s72, s70, s72
    s_lshl_b32 s43, s72, 5
    s_add_u32 s43, s43, s71
    s_mov_b32 s36, s70
    s_mov_b32 s41, s71
    s_and_b32 s70, s43, 7
    s_lshr_b32 s71, s43, 3
    s_setprio 2
    s_mov_b32 s44, s16
    s_mov_b32 s45, s17
    s_mov_b32 s46, 896
    s_mov_b32 s47, 0x00020000
    s_mov_b32 s48, s28
    s_mov_b32 s49, s29
    s_mov_b32 s50, 1605632
    s_mov_b32 s51, 0x00020000
    s_mov_b32 s56, s32
    s_mov_b32 s57, s33
    s_mov_b32 s58, 1605632
    s_mov_b32 s59, 0x00020000
    s_mov_b32 s60, s30
    s_mov_b32 s61, s31
    s_mov_b32 s62, 3584
    s_mov_b32 s63, 0x00020000
    v_lshlrev_b32 v2, 4, v1
    buffer_load_dwordx4 v[4:7], v2, s[44:47], 0 offen
    v_lshrrev_b32 v3, 3, v1
    s_movk_i32 s74, 3584
    v_mul_lo_u32 v8, v3, s74
    v_and_b32 v9, 7, v1
    v_lshl_add_u32 v8, v9, 4, v8
    s_mul_i32 s72, s70, 200704
    s_lshl_b32 s73, s71, 7
    s_add_u32 s72, s72, s73
    v_add_u32 v8, s72, v8
    s_mov_b32 s74, 0
    buffer_load_dwordx4 v[32:35], v8, s[48:51], s74 offen nt
    s_mov_b32 s75, 28672
    buffer_load_dwordx4 v[36:39], v8, s[48:51], s75 offen nt
    s_mov_b32 s74, 57344
    buffer_load_dwordx4 v[40:43], v8, s[48:51], s74 offen nt
    s_mov_b32 s75, 86016
    buffer_load_dwordx4 v[44:47], v8, s[48:51], s75 offen nt
    s_mov_b32 s74, 114688
    buffer_load_dwordx4 v[48:51], v8, s[48:51], s74 offen nt
    s_mov_b32 s75, 143360
    buffer_load_dwordx4 v[52:55], v8, s[48:51], s75 offen nt
    s_mov_b32 s74, 172032
    buffer_load_dwordx4 v[56:59], v8, s[48:51], s74 offen nt
    v_and_b32 v31, 7, v1
    v_lshlrev_b32 v31, 6, v31
    v_lshrrev_b32 v30, 5, v1
    v_lshl_add_u32 v31, v30, 5, v31
    v_bfe_u32 v30, v1, 4, 1
    v_lshl_add_u32 v31, v30, 4, v31
    s_lshl_b32 s72, s43, 9
    s_add_u32 s72, s72, 131072
    v_add_u32 v31, s72, v31
    s_barrier
    v_cmp_gt_u32 vcc, 56, v1
    s_nop 1
    v_cndmask_b32 v9, 0, 1.0, vcc
    s_waitcnt vmcnt(7)
    v_lshlrev_b32 v10, 16, v4
    v_and_b32 v11, 0xffff0000, v4
    v_lshlrev_b32 v12, 16, v5
    v_and_b32 v13, 0xffff0000, v5
    v_lshlrev_b32 v14, 16, v6
    v_and_b32 v15, 0xffff0000, v6
    v_lshlrev_b32 v16, 16, v7
    v_and_b32 v17, 0xffff0000, v7
    v_add_f32 v18, v10, v11
    v_add_f32 v19, v12, v13
    v_add_f32 v20, v14, v15
    v_add_f32 v21, v16, v17
    v_add_f32 v18, v18, v19
    v_add_f32 v20, v20, v21
    v_add_f32 v18, v18, v20
    s_nop 1
    v_add_f32_dpp v18, v18, v18 quad_perm:[1,0,3,2] row_mask:0xf bank_mask:0xf
    s_nop 1
    v_add_f32_dpp v18, v18, v18 quad_perm:[2,3,0,1] row_mask:0xf bank_mask:0xf
    s_nop 1
    v_add_f32_dpp v18, v18, v18 row_half_mirror row_mask:0xf bank_mask:0xf
    s_nop 1
    v_add_f32_dpp v18, v18, v18 row_mirror row_mask:0xf bank_mask:0xf
    s_nop 1
    v_mov_b32 v19, v18
    s_nop 1
    v_permlane16_swap_b32 v18, v19
    v_add_f32 v18, v18, v19
    s_nop 1
    v_mov_b32 v19, v18
    s_nop 1
    v_permlane32_swap_b32 v18, v19
    v_add_f32 v18, v18, v19
    s_nop 1
    v_mul_f32 v18, 0x3b124925, v18
    v_mov_b32 v20, 0
    v_sub_f32 v19, v10, v18
    v_fmac_f32 v20, v19, v19
    v_sub_f32 v19, v11, v18
    v_fmac_f32 v20, v19, v19
    v_sub_f32 v19, v12, v18
    v_fmac_f32 v20, v19, v19
    v_sub_f32 v19, v13, v18
    v_fmac_f32 v20, v19, v19
    v_sub_f32 v19, v14, v18
    v_fmac_f32 v20, v19, v19
    v_sub_f32 v19, v15, v18
    v_fmac_f32 v20, v19, v19
    v_sub_f32 v19, v16, v18
    v_fmac_f32 v20, v19, v19
    v_sub_f32 v19, v17, v18
    v_fmac_f32 v20, v19, v19
    v_mul_f32 v20, v20, v9
    s_nop 1
    v_add_f32_dpp v20, v20, v20 quad_perm:[1,0,3,2] row_mask:0xf bank_mask:0xf
    s_nop 1
    v_add_f32_dpp v20, v20, v20 quad_perm:[2,3,0,1] row_mask:0xf bank_mask:0xf
    s_nop 1
    v_add_f32_dpp v20, v20, v20 row_half_mirror row_mask:0xf bank_mask:0xf
    s_nop 1
    v_add_f32_dpp v20, v20, v20 row_mirror row_mask:0xf bank_mask:0xf
    s_nop 1
    v_mov_b32 v19, v20
    s_nop 1
    v_permlane16_swap_b32 v20, v19
    v_add_f32 v20, v20, v19
    s_nop 1
    v_mov_b32 v19, v20
    s_nop 1
    v_permlane32_swap_b32 v20, v19
    v_add_f32 v20, v20, v19
    s_nop 1
    v_mul_f32 v20, 0x3b124925, v20
    v_cvt_pk_bf16_f32 v18, v18, v18
    v_lshlrev_b32 v18, 16, v18
    v_cvt_pk_bf16_f32 v20, v20, v20
    v_lshlrev_b32 v20, 16, v20
    v_add_f32 v20, 0x3727c5ac, v20
    v_cvt_pk_bf16_f32 v20, v20, v20
    v_lshlrev_b32 v20, 16, v20
    v_sqrt_f32 v20, v20
    s_nop 0
    v_cvt_pk_bf16_f32 v20, v20, v20
    v_lshlrev_b32 v20, 16, v20
    v_rcp_f32 v20, v20
    s_nop 0
    v_sub_f32 v10, v10, v18
    v_cvt_pk_bf16_f32 v10, v10, v10
    v_lshlrev_b32 v10, 16, v10
    v_mul_f32 v10, v10, v20
    v_cvt_pk_bf16_f32 v10, v10, v10
    v_lshlrev_b32 v10, 16, v10
    v_mul_f32 v10, v10, v9
    v_sub_f32 v11, v11, v18
    v_cvt_pk_bf16_f32 v11, v11, v11
    v_lshlrev_b32 v11, 16, v11
    v_mul_f32 v11, v11, v20
    v_cvt_pk_bf16_f32 v11, v11, v11
    v_lshlrev_b32 v11, 16, v11
    v_mul_f32 v11, v11, v9
    v_sub_f32 v12, v12, v18
    v_cvt_pk_bf16_f32 v12, v12, v12
    v_lshlrev_b32 v12, 16, v12
    v_mul_f32 v12, v12, v20
    v_cvt_pk_bf16_f32 v12, v12, v12
    v_lshlrev_b32 v12, 16, v12
    v_mul_f32 v12, v12, v9
    v_sub_f32 v13, v13, v18
    v_cvt_pk_bf16_f32 v13, v13, v13
    v_lshlrev_b32 v13, 16, v13
    v_mul_f32 v13, v13, v20
    v_cvt_pk_bf16_f32 v13, v13, v13
    v_lshlrev_b32 v13, 16, v13
    v_mul_f32 v13, v13, v9
    v_sub_f32 v14, v14, v18
    v_cvt_pk_bf16_f32 v14, v14, v14
    v_lshlrev_b32 v14, 16, v14
    v_mul_f32 v14, v14, v20
    v_cvt_pk_bf16_f32 v14, v14, v14
    v_lshlrev_b32 v14, 16, v14
    v_mul_f32 v14, v14, v9
    v_sub_f32 v15, v15, v18
    v_cvt_pk_bf16_f32 v15, v15, v15
    v_lshlrev_b32 v15, 16, v15
    v_mul_f32 v15, v15, v20
    v_cvt_pk_bf16_f32 v15, v15, v15
    v_lshlrev_b32 v15, 16, v15
    v_mul_f32 v15, v15, v9
    v_sub_f32 v16, v16, v18
    v_cvt_pk_bf16_f32 v16, v16, v16
    v_lshlrev_b32 v16, 16, v16
    v_mul_f32 v16, v16, v20
    v_cvt_pk_bf16_f32 v16, v16, v16
    v_lshlrev_b32 v16, 16, v16
    v_mul_f32 v16, v16, v9
    v_sub_f32 v17, v17, v18
    v_cvt_pk_bf16_f32 v17, v17, v17
    v_lshlrev_b32 v17, 16, v17
    v_mul_f32 v17, v17, v20
    v_cvt_pk_bf16_f32 v17, v17, v17
    v_lshlrev_b32 v17, 16, v17
    v_mul_f32 v17, v17, v9
    v_add_f32 v18, v10, v11
    v_add_f32 v19, v12, v13
    v_add_f32 v20, v14, v15
    v_add_f32 v21, v16, v17
    v_add_f32 v18, v18, v19
    v_add_f32 v20, v20, v21
    v_add_f32 v18, v18, v20
    s_nop 1
    v_add_f32_dpp v18, v18, v18 quad_perm:[1,0,3,2] row_mask:0xf bank_mask:0xf
    s_nop 1
    v_add_f32_dpp v18, v18, v18 quad_perm:[2,3,0,1] row_mask:0xf bank_mask:0xf
    s_nop 1
    v_add_f32_dpp v18, v18, v18 row_half_mirror row_mask:0xf bank_mask:0xf
    s_nop 1
    v_add_f32_dpp v18, v18, v18 row_mirror row_mask:0xf bank_mask:0xf
    s_nop 1
    v_mov_b32 v19, v18
    s_nop 1
    v_permlane16_swap_b32 v18, v19
    v_add_f32 v18, v18, v19
    s_nop 1
    v_mov_b32 v19, v18
    s_nop 1
    v_permlane32_swap_b32 v18, v19
    v_add_f32 v18, v18, v19
    s_nop 1
    v_mul_f32 v18, 0x3b124925, v18
    v_mov_b32 v20, 0
    v_sub_f32 v19, v10, v18
    v_fmac_f32 v20, v19, v19
    v_sub_f32 v19, v11, v18
    v_fmac_f32 v20, v19, v19
    v_sub_f32 v19, v12, v18
    v_fmac_f32 v20, v19, v19
    v_sub_f32 v19, v13, v18
    v_fmac_f32 v20, v19, v19
    v_sub_f32 v19, v14, v18
    v_fmac_f32 v20, v19, v19
    v_sub_f32 v19, v15, v18
    v_fmac_f32 v20, v19, v19
    v_sub_f32 v19, v16, v18
    v_fmac_f32 v20, v19, v19
    v_sub_f32 v19, v17, v18
    v_fmac_f32 v20, v19, v19
    v_mul_f32 v20, v20, v9
    s_nop 1
    v_add_f32_dpp v20, v20, v20 quad_perm:[1,0,3,2] row_mask:0xf bank_mask:0xf
    s_nop 1
    v_add_f32_dpp v20, v20, v20 quad_perm:[2,3,0,1] row_mask:0xf bank_mask:0xf
    s_nop 1
    v_add_f32_dpp v20, v20, v20 row_half_mirror row_mask:0xf bank_mask:0xf
    s_nop 1
    v_add_f32_dpp v20, v20, v20 row_mirror row_mask:0xf bank_mask:0xf
    s_nop 1
    v_mov_b32 v19, v20
    s_nop 1
    v_permlane16_swap_b32 v20, v19
    v_add_f32 v20, v20, v19
    s_nop 1
    v_mov_b32 v19, v20
    s_nop 1
    v_permlane32_swap_b32 v20, v19
    v_add_f32 v20, v20, v19
    s_nop 1
    v_mul_f32 v20, 0x3b124925, v20
    v_cvt_pk_bf16_f32 v18, v18, v18
    v_lshlrev_b32 v18, 16, v18
    v_cvt_pk_bf16_f32 v20, v20, v20
    v_lshlrev_b32 v20, 16, v20
    v_add_f32 v20, 0x3727c5ac, v20
    v_cvt_pk_bf16_f32 v20, v20, v20
    v_lshlrev_b32 v20, 16, v20
    v_sqrt_f32 v20, v20
    s_nop 0
    v_cvt_pk_bf16_f32 v20, v20, v20
    v_lshlrev_b32 v20, 16, v20
    v_rcp_f32 v20, v20
    s_nop 0
    v_sub_f32 v10, v10, v18
    v_cvt_pk_bf16_f32 v10, v10, v10
    v_lshlrev_b32 v10, 16, v10
    v_mul_f32 v10, v10, v20
    v_cvt_pk_bf16_f32 v10, v10, v10
    v_lshlrev_b32 v10, 16, v10
    v_mul_f32 v10, v10, v9
    v_sub_f32 v11, v11, v18
    v_cvt_pk_bf16_f32 v11, v11, v11
    v_lshlrev_b32 v11, 16, v11
    v_mul_f32 v11, v11, v20
    v_cvt_pk_bf16_f32 v11, v11, v11
    v_lshlrev_b32 v11, 16, v11
    v_mul_f32 v11, v11, v9
    v_sub_f32 v12, v12, v18
    v_cvt_pk_bf16_f32 v12, v12, v12
    v_lshlrev_b32 v12, 16, v12
    v_mul_f32 v12, v12, v20
    v_cvt_pk_bf16_f32 v12, v12, v12
    v_lshlrev_b32 v12, 16, v12
    v_mul_f32 v12, v12, v9
    v_sub_f32 v13, v13, v18
    v_cvt_pk_bf16_f32 v13, v13, v13
    v_lshlrev_b32 v13, 16, v13
    v_mul_f32 v13, v13, v20
    v_cvt_pk_bf16_f32 v13, v13, v13
    v_lshlrev_b32 v13, 16, v13
    v_mul_f32 v13, v13, v9
    v_sub_f32 v14, v14, v18
    v_cvt_pk_bf16_f32 v14, v14, v14
    v_lshlrev_b32 v14, 16, v14
    v_mul_f32 v14, v14, v20
    v_cvt_pk_bf16_f32 v14, v14, v14
    v_lshlrev_b32 v14, 16, v14
    v_mul_f32 v14, v14, v9
    v_sub_f32 v15, v15, v18
    v_cvt_pk_bf16_f32 v15, v15, v15
    v_lshlrev_b32 v15, 16, v15
    v_mul_f32 v15, v15, v20
    v_cvt_pk_bf16_f32 v15, v15, v15
    v_lshlrev_b32 v15, 16, v15
    v_mul_f32 v15, v15, v9
    v_sub_f32 v16, v16, v18
    v_cvt_pk_bf16_f32 v16, v16, v16
    v_lshlrev_b32 v16, 16, v16
    v_mul_f32 v16, v16, v20
    v_cvt_pk_bf16_f32 v16, v16, v16
    v_lshlrev_b32 v16, 16, v16
    v_mul_f32 v16, v16, v9
    v_sub_f32 v17, v17, v18
    v_cvt_pk_bf16_f32 v17, v17, v17
    v_lshlrev_b32 v17, 16, v17
    v_mul_f32 v17, v17, v20
    v_cvt_pk_bf16_f32 v17, v17, v17
    v_lshlrev_b32 v17, 16, v17
    v_mul_f32 v17, v17, v9
    v_lshlrev_b32 v18, 5, v1
    ds_write_b128 v18, v[10:13] offset:2048
    ds_write_b128 v18, v[14:17] offset:2064
    s_mul_i32 s72, s70, 224
    v_lshl_add_u32 v18, v3, 2, s72
    ds_read_b32 v88, v18 offset:2048
    ds_read_b32 v89, v18 offset:2080
    ds_read_b32 v90, v18 offset:2112
    ds_read_b32 v91, v18 offset:2144
    ds_read_b32 v92, v18 offset:2176
    ds_read_b32 v93, v18 offset:2208
    ds_read_b32 v94, v18 offset:2240
    v_mov_b32 v104, 0
    v_mov_b32 v105, 0
    v_mov_b32 v106, 0
    v_mov_b32 v107, 0
    v_mov_b32 v108, 0
    v_mov_b32 v109, 0
    v_mov_b32 v110, 0
    v_mov_b32 v111, 0
    s_waitcnt lgkmcnt(0)
    s_mul_i32 s68, s42, 1664525
    s_add_u32 s68, s68, 1013904223
    s_xor_b32 s69, s42, 0x5bd1e995
    s_mul_i32 s69, s69, 0x9E3779B1
    s_add_u32 s69, s69, 0x7F4A7C15
    s_waitcnt vmcnt(6)
    v_lshlrev_b32 v112, 16, v32
    v_and_b32 v113, 0xffff0000, v32
    v_lshlrev_b32 v114, 16, v33
    v_and_b32 v115, 0xffff0000, v33
    v_lshlrev_b32 v116, 16, v34
    v_and_b32 v117, 0xffff0000, v34
    v_lshlrev_b32 v118, 16, v35
    v_and_b32 v119, 0xffff0000, v35
    v_fmac_f32 v104, v112, v88
    v_fmac_f32 v105, v113, v88
    v_fmac_f32 v106, v114, v88
    v_fmac_f32 v107, v115, v88
    v_fmac_f32 v108, v116, v88
    v_fmac_f32 v109, v117, v88
    v_fmac_f32 v110, v118, v88
    v_fmac_f32 v111, v119, v88
    s_waitcnt vmcnt(5)
    v_lshlrev_b32 v112, 16, v36
    v_and_b32 v113, 0xffff0000, v36
    v_lshlrev_b32 v114, 16, v37
    v_and_b32 v115, 0xffff0000, v37
    v_lshlrev_b32 v116, 16, v38
    v_and_b32 v117, 0xffff0000, v38
    v_lshlrev_b32 v118, 16, v39
    v_and_b32 v119, 0xffff0000, v39
    v_fmac_f32 v104, v112, v89
    v_fmac_f32 v105, v113, v89
    v_fmac_f32 v106, v114, v89
    v_fmac_f32 v107, v115, v89
    v_fmac_f32 v108, v116, v89
    v_fmac_f32 v109, v117, v89
    v_fmac_f32 v110, v118, v89
    v_fmac_f32 v111, v119, v89
    s_waitcnt vmcnt(4)
    v_lshlrev_b32 v112, 16, v40
    v_and_b32 v113, 0xffff0000, v40
    v_lshlrev_b32 v114, 16, v41
    v_and_b32 v115, 0xffff0000, v41
    v_lshlrev_b32 v116, 16, v42
    v_and_b32 v117, 0xffff0000, v42
    v_lshlrev_b32 v118, 16, v43
    v_and_b32 v119, 0xffff0000, v43
    v_fmac_f32 v104, v112, v90
    v_fmac_f32 v105, v113, v90
    v_fmac_f32 v106, v114, v90
    v_fmac_f32 v107, v115, v90
    v_fmac_f32 v108, v116, v90
    v_fmac_f32 v109, v117, v90
    v_fmac_f32 v110, v118, v90
    v_fmac_f32 v111, v119, v90
    s_waitcnt vmcnt(3)
    v_lshlrev_b32 v112, 16, v44
    v_and_b32 v113, 0xffff0000, v44
    v_lshlrev_b32 v114, 16, v45
    v_and_b32 v115, 0xffff0000, v45
    v_lshlrev_b32 v116, 16, v46
    v_and_b32 v117, 0xffff0000, v46
    v_lshlrev_b32 v118, 16, v47
    v_and_b32 v119, 0xffff0000, v47
    v_fmac_f32 v104, v112, v91
    v_fmac_f32 v105, v113, v91
    v_fmac_f32 v106, v114, v91
    v_fmac_f32 v107, v115, v91
    v_fmac_f32 v108, v116, v91
    v_fmac_f32 v109, v117, v91
    v_fmac_f32 v110, v118, v91
    v_fmac_f32 v111, v119, v91
    s_waitcnt vmcnt(2)
    v_lshlrev_b32 v112, 16, v48
    v_and_b32 v113, 0xffff0000, v48
    v_lshlrev_b32 v114, 16, v49
    v_and_b32 v115, 0xffff0000, v49
    v_lshlrev_b32 v116, 16, v50
    v_and_b32 v117, 0xffff0000, v50
    v_lshlrev_b32 v118, 16, v51
    v_and_b32 v119, 0xffff0000, v51
    v_fmac_f32 v104, v112, v92
    v_fmac_f32 v105, v113, v92
    v_fmac_f32 v106, v114, v92
    v_fmac_f32 v107, v115, v92
    v_fmac_f32 v108, v116, v92
    v_fmac_f32 v109, v117, v92
    v_fmac_f32 v110, v118, v92
    v_fmac_f32 v111, v119, v92
    s_waitcnt vmcnt(1)
    v_lshlrev_b32 v112, 16, v52
    v_and_b32 v113, 0xffff0000, v52
    v_lshlrev_b32 v114, 16, v53
    v_and_b32 v115, 0xffff0000, v53
    v_lshlrev_b32 v116, 16, v54
    v_and_b32 v117, 0xffff0000, v54
    v_lshlrev_b32 v118, 16, v55
    v_and_b32 v119, 0xffff0000, v55
    v_fmac_f32 v104, v112, v93
    v_fmac_f32 v105, v113, v93
    v_fmac_f32 v106, v114, v93
    v_fmac_f32 v107, v115, v93
    v_fmac_f32 v108, v116, v93
    v_fmac_f32 v109, v117, v93
    v_fmac_f32 v110, v118, v93
    v_fmac_f32 v111, v119, v93
    s_waitcnt vmcnt(0)
    v_lshlrev_b32 v112, 16, v56
    v_and_b32 v113, 0xffff0000, v56
    v_lshlrev_b32 v114, 16, v57
    v_and_b32 v115, 0xffff0000, v57
    v_lshlrev_b32 v116, 16, v58
    v_and_b32 v117, 0xffff0000, v58
    v_lshlrev_b32 v118, 16, v59
    v_and_b32 v119, 0xffff0000, v59
    v_fmac_f32 v104, v112, v94
    v_fmac_f32 v105, v113, v94
    v_fmac_f32 v106, v114, v94
    v_fmac_f32 v107, v115, v94
    v_fmac_f32 v108, v116, v94
    v_fmac_f32 v109, v117, v94
    v_fmac_f32 v110, v118, v94
    v_fmac_f32 v111, v119, v94
    s_nop 1
    v_permlane32_swap_b32 v104, v108
    v_permlane32_swap_b32 v105, v109
    v_permlane32_swap_b32 v106, v110
    v_permlane32_swap_b32 v107, v111
    v_add_f32 v104, v104, v108
    v_add_f32 v105, v105, v109
    v_add_f32 v106, v106, v110
    v_add_f32 v107, v107, v111
    s_nop 1
    v_permlane16_swap_b32 v104, v106
    v_permlane16_swap_b32 v105, v107
    v_add_f32 v104, v104, v106
    v_add_f32 v105, v105, v107
    s_nop 1
    v_add_f32_dpp v104, v104, v104 row_ror:8 row_mask:0xf bank_mask:0xf
    v_add_f32_dpp v105, v105, v105 row_ror:8 row_mask:0xf bank_mask:0xf
    s_nop 0
    v_mov_b32 v112, v104
    v_mov_b32 v113, s68
    v_mov_b32 v114, v105
    v_mov_b32 v115, s69
    s_mov_b32 exec_lo, 0x00ff00ff
    s_mov_b32 exec_hi, 0x00ff00ff
    s_mov_b32 s74, 4194304
    buffer_store_dwordx4 v[112:115], v31, s[52:55], 0 offen
    buffer_store_dwordx4 v[112:115], v31, s[52:55], s74 offen sc1
    s_mov_b64 exec, -1
    v_and_b32 v23, 15, v1
    v_lshrrev_b32 v24, 4, v1
    s_movk_i32 s74, 896
    v_mul_lo_u32 v25, v24, s74
    v_lshl_add_u32 v25, v23, 4, v25
    s_mul_i32 s72, s43, 7168
    v_add_u32 v25, s72, v25
    v_bfe_u32 v26, v1, 3, 2
    v_lshlrev_b32 v26, 2, v26
    s_lshl_b32 s72, s43, 4
    v_add_u32 v26, s72, v26
    buffer_load_dword v27, v26, s[60:63], 0 offen
    v_and_b32 v14, 1, v1
    v_lshlrev_b32 v14, 4, v14
    v_mov_b32 v15, 0xffff
    v_lshlrev_b32 v15, v14, v15
    v_bfe_u32 v14, v1, 1, 3
    v_cmp_eq_u32 vcc, 0, v14
    s_nop 1
    v_cndmask_b32 v10, 0, v15, vcc
    v_cmp_eq_u32 vcc, 1, v14
    s_nop 1
    v_cndmask_b32 v11, 0, v15, vcc
    v_cmp_eq_u32 vcc, 2, v14
    s_nop 1
    v_cndmask_b32 v12, 0, v15, vcc
    v_cmp_eq_u32 vcc, 3, v14
    s_nop 1
    v_cndmask_b32 v13, 0, v15, vcc
    v_lshrrev_b32 v14, 1, v24
    v_lshlrev_b32 v14, 5, v14
    v_add_u32 v15, 64, v14
    v_and_b32 v29, 1, v24
    v_cmp_eq_u32 vcc, 1, v29
    v_mov_b32 v29, 0x01000100
    v_mov_b32 v28, 0x03020302
    v_cndmask_b32 v29, v29, v28, vcc
    v_bfe_u32 v30, v1, 2, 2
    v_lshrrev_b32 v31, 5, v1
    v_lshl_add_u32 v30, v31, 2, v30
    v_mul_u32_u24 v30, 4224, v30
    v_and_b32 v31, 3, v1
    v_lshl_add_u32 v30, v31, 5, v30
    v_bfe_u32 v31, v1, 4, 1
    v_lshl_add_u32 v30, v31, 4, v30
    s_mul_i32 s72, s36, 59136
    s_lshl_b32 s73, s41, 7
    s_add_u32 s72, s72, s73
    s_add_u32 s72, s72, 2097152
    v_add_u32 v30, s72, v30
    v_and_b32 v18, 7, v1
    v_lshlrev_b32 v18, 9, v18
    v_bfe_u32 v19, v1, 3, 2
    v_lshl_add_u32 v18, v19, 4, v18
    s_lshl_b32 s72, s71, 12
    s_lshl_b32 s73, s70, 6
    s_add_u32 s72, s72, s73
    s_add_u32 s72, s72, 131072
    v_add_u32 v18, s72, v18
    v_mov_b32 v22, 0
    s_mov_b32 s77, 0
L_m_k:
    ds_read_b64 v[20:21], v22 offset:4104
    s_waitcnt lgkmcnt(0)
    v_cmp_eq_u32 vcc, s68, v20
    v_cmp_eq_u32 s[78:79], s69, v21
    s_and_b64 vcc, vcc, s[78:79]
    s_cmp_eq_u64 vcc, -1
    s_cbranch_scc1 L_m_k_done
    s_sleep 4
    s_add_u32 s77, s77, 1
    s_cmp_lt_u32 s77, 2000000
    s_cbranch_scc1 L_m_k
L_m_k_done:
    s_mov_b32 s77, 0
    s_mov_b32 s38, 0
    buffer_load_dwordx4 v[96:99], v18, s[52:55], s38 offen sc1
    s_branch L_m_h_chk
L_m_h:
    s_cmp_ge_u32 s77, 8
    s_cselect_b32 s39, 4194304, 0
    s_xor_b32 s38, s38, s39
    s_cmp_eq_u64 s[4:5], 0
    s_cbranch_scc1 L_m_h_s0
    s_mov_b64 exec, s[4:5]
    buffer_load_dwordx4 v[96:99], v18, s[52:55], s38 offen sc1
L_m_h_s0:
    s_mov_b64 exec, -1
L_m_h_chk:
    s_waitcnt vmcnt(0)
    v_cmp_ne_u32 s[4:5], s68, v97
    v_cmp_ne_u32 vcc, s69, v99
    s_or_b64 s[4:5], s[4:5], vcc
    s_mov_b64 s[78:79], s[4:5]
    s_cmp_eq_u64 s[78:79], 0
    s_cbranch_scc1 L_m_h_done
    s_add_u32 s77, s77, 1
    s_cmp_lt_u32 s77, 200000
    s_cbranch_scc1 L_m_h
L_m_h_done:
    v_mov_b32 v22, 0
    s_mov_b32 s77, 0
L_m_i:
    ds_read_b64 v[20:21], v22 offset:4112
    s_waitcnt lgkmcnt(0)
    v_cmp_eq_u32 vcc, s68, v20
    v_cmp_eq_u32 s[78:79], s69, v21
    s_and_b64 vcc, vcc, s[78:79]
    s_cmp_eq_u64 vcc, -1
    s_cbranch_scc1 L_m_i_done
    s_sleep 4
    s_add_u32 s77, s77, 1
    s_cmp_lt_u32 s77, 2000000
    s_cbranch_scc1 L_m_i
L_m_i_done:
    s_movk_i32 s75, 3584
    buffer_load_dwordx4 v[32:35], v25, s[56:59], 0 offen offset:0 nt
    buffer_load_dwordx4 v[36:39], v25, s[56:59], 0 offen offset:256 nt
    buffer_load_dwordx4 v[40:43], v25, s[56:59], 0 offen offset:512 nt
    buffer_load_dwordx4 v[44:47], v25, s[56:59], 0 offen offset:768 nt
    buffer_load_dwordx4 v[48:51], v25, s[56:59], s75 offen offset:0 nt
    buffer_load_dwordx4 v[52:55], v25, s[56:59], s75 offen offset:256 nt
    buffer_load_dwordx4 v[56:59], v25, s[56:59], s75 offen offset:512 nt
    buffer_load_dwordx4 v[60:63], v25, s[56:59], s75 offen offset:768 nt
    v_mov_b32 v20, v96
    v_mov_b32 v21, v98
    s_nop 1
    v_add_f32_dpp v20, v20, v20 quad_perm:[1,0,3,2] row_mask:0xf bank_mask:0xf
    v_add_f32_dpp v21, v21, v21 quad_perm:[1,0,3,2] row_mask:0xf bank_mask:0xf
    s_nop 0
    v_add_f32_dpp v20, v20, v20 quad_perm:[2,3,0,1] row_mask:0xf bank_mask:0xf
    v_add_f32_dpp v21, v21, v21 quad_perm:[2,3,0,1] row_mask:0xf bank_mask:0xf
    s_nop 0
    v_add_f32_dpp v20, v20, v20 row_half_mirror row_mask:0xf bank_mask:0xf
    v_add_f32_dpp v21, v21, v21 row_half_mirror row_mask:0xf bank_mask:0xf
    s_nop 0
    v_cvt_pk_bf16_f32 v20, v20, v20
    v_lshlrev_b32 v20, 16, v20
    v_cvt_pk_bf16_f32 v21, v21, v21
    v_lshlrev_b32 v21, 16, v21
    v_lshlrev_b32 v22, 16, v27
    v_and_b32 v23, 0xffff0000, v27
    v_add_f32 v20, v20, v22
    v_add_f32 v21, v21, v23
    v_cvt_pk_bf16_f32 v20, v20, v20
    v_lshlrev_b32 v20, 16, v20
    v_cvt_pk_bf16_f32 v21, v21, v21
    v_lshlrev_b32 v21, 16, v21
    s_mov_b32 s72, 0x3d372713
    s_mov_b32 s73, 0xc0135761
    v_mul_f32 v22, v20, v20
    v_mul_f32 v22, v22, v20
    v_fma_f32 v22, v22, s72, v20
    v_mul_f32 v22, s73, v22
    v_exp_f32 v22, v22
    s_nop 0
    v_add_f32 v22, 1.0, v22
    v_rcp_f32 v22, v22
    s_nop 0
    v_mul_f32 v20, v20, v22
    v_mul_f32 v23, v21, v21
    v_mul_f32 v23, v23, v21
    v_fma_f32 v23, v23, s72, v21
    v_mul_f32 v23, s73, v23
    v_exp_f32 v23, v23
    s_nop 0
    v_add_f32 v23, 1.0, v23
    v_rcp_f32 v23, v23
    s_nop 0
    v_mul_f32 v21, v21, v23
    v_cvt_pk_bf16_f32 v21, v20, v21
    s_nop 0
    ds_bpermute_b32 v96, v14, v21
    ds_bpermute_b32 v97, v15, v21
    s_waitcnt lgkmcnt(0)
    v_perm_b32 v96, v96, v96, v29
    v_perm_b32 v97, v97, v97, v29
    v_and_b32 v100, v96, v10
    v_and_b32 v101, v96, v11
    v_and_b32 v102, v96, v12
    v_and_b32 v103, v96, v13
    v_and_b32 v104, v97, v10
    v_and_b32 v105, v97, v11
    v_and_b32 v106, v97, v12
    v_and_b32 v107, v97, v13
    s_waitcnt vmcnt(0)
    v_mfma_f32_16x16x32_bf16 v[112:115], v[100:103], v[32:35], 0
    v_mfma_f32_16x16x32_bf16 v[116:119], v[100:103], v[36:39], 0
    v_mfma_f32_16x16x32_bf16 v[120:123], v[100:103], v[40:43], 0
    v_mfma_f32_16x16x32_bf16 v[124:127], v[100:103], v[44:47], 0
    v_mfma_f32_16x16x32_bf16 v[112:115], v[104:107], v[48:51], v[112:115]
    v_mfma_f32_16x16x32_bf16 v[116:119], v[104:107], v[52:55], v[116:119]
    v_mfma_f32_16x16x32_bf16 v[120:123], v[104:107], v[56:59], v[120:123]
    v_mfma_f32_16x16x32_bf16 v[124:127], v[104:107], v[60:63], v[124:127]
    s_nop 7
    v_mov_b32 v22, 0
    s_mov_b32 s77, 0
L_m_q:
    ds_read_b64 v[20:21], v22 offset:4096
    s_waitcnt lgkmcnt(0)
    v_cmp_eq_u32 vcc, s68, v20
    v_cmp_eq_u32 s[78:79], s69, v21
    s_and_b64 vcc, vcc, s[78:79]
    s_cmp_eq_u64 vcc, -1
    s_cbranch_scc1 L_m_q_done
    s_sleep 2
    s_add_u32 s77, s77, 1
    s_cmp_lt_u32 s77, 2000000
    s_cbranch_scc1 L_m_q
L_m_q_done:
    ds_read_b32 v20, v22 offset:4120
    s_waitcnt lgkmcnt(0)
    v_readfirstlane_b32 s37, v20
    v_cvt_pk_bf16_f32 v96, v112, v113
    v_cvt_pk_bf16_f32 v98, v114, v115
    v_cvt_pk_bf16_f32 v116, v116, v117
    v_cvt_pk_bf16_f32 v118, v118, v119
    v_mov_b32 v97, s68
    v_mov_b32 v99, s69
    v_cvt_pk_bf16_f32 v100, v120, v121
    v_cvt_pk_bf16_f32 v102, v122, v123
    v_cvt_pk_bf16_f32 v124, v124, v125
    v_cvt_pk_bf16_f32 v126, v126, v127
    v_mov_b32 v101, s68
    v_mov_b32 v103, s69
    s_mov_b32 s74, 33792
    v_permlane32_swap_b32 v96, v116
    v_permlane32_swap_b32 v98, v118
    v_permlane32_swap_b32 v100, v124
    v_permlane32_swap_b32 v102, v126
    buffer_store_dwordx4 v[96:99], v30, s[52:55], 0 offen
    s_mov_b32 exec_hi, 0x00ff00ff
    buffer_store_dwordx4 v[100:103], v30, s[52:55], s74 offen
    s_cmp_eq_u32 s37, 0
    s_cbranch_scc1 L_m_nos
    s_mov_b32 s74, 4228096
    s_mov_b32 s75, 4194304
    buffer_store_dwordx4 v[100:103], v30, s[52:55], s74 offen sc1
    s_mov_b64 exec, -1
    buffer_store_dwordx4 v[96:99], v30, s[52:55], s75 offen sc1
L_m_nos:
    s_mov_b64 exec, -1
L_end:
    s_endpgm
.section .rodata,"a"
.p2align 6
.amdhsa_kernel parallel_sum__sliding_block_cached__mixer_channel_mlp__decode_kernel
  .amdhsa_next_free_vgpr 128
  .amdhsa_next_free_sgpr 102
  .amdhsa_accum_offset 128
  .amdhsa_group_segment_fixed_size 0
  .amdhsa_kernarg_size 104
  .amdhsa_user_sgpr_count 2
  .amdhsa_user_sgpr_kernarg_segment_ptr 1
  .amdhsa_system_sgpr_workgroup_id_x 1
  .amdhsa_float_denorm_mode_32 3
  .amdhsa_float_denorm_mode_16_64 3
.end_amdhsa_kernel
```
